```python
import torch

def _softmax(x, axis=-1):
    return torch.softmax(x, dim=axis)
def _gelu(x):
    return torch.nn.functional.gelu(x, approximate="tanh")
def _silu(x):
    return torch.nn.functional.silu(x)
def _sigmoid(x):
    return torch.sigmoid(x)
def _layernorm(x, axis=-1, eps=1e-5):
    m = x.mean(dim=axis, keepdim=True)
    v = x.var(dim=axis, keepdim=True, unbiased=False)
    return (x - m) / torch.sqrt(v + eps)
def _scatter_add(tgt, idx, src, axis=0):
    return tgt.clone().index_add_(axis, idx, src)
def _segment_sum(src, seg, n):
    out = torch.zeros((n,) + src.shape[1:], dtype=src.dtype)
    return out.index_add_(0, seg, src)
def _pad(x, pw):
    flat = tuple(v for pair in reversed(pw) for v in pair)
    return torch.nn.functional.pad(x, flat)

kernel_name = 'sequential_preLN__softmax_full_mha__dense_activation_gelu__prompt'

def setup_inputs():

    _w = (lambda a: (lambda t: t.to(torch.bfloat16) if t.is_floating_point() else t)(torch.as_tensor(a)))
    def _A_setup():
        B, S, D = 1, 2048, 1024
        return {
            "x": _w((lambda *s: torch.randn(*s, dtype=torch.bfloat16) * 0.05)(B, S, D)),
            "wqkv": _w((lambda *s: torch.randn(*s, dtype=torch.bfloat16) * 0.05)(D, 3 * D)),
            "wo": _w((lambda *s: torch.randn(*s, dtype=torch.bfloat16) * 0.05)(D, D)),
        }
    _A_in = _A_setup()

    def _B_setup():
        B, S, D, F = 1, 2048, 1024, 3584
        return {
            "x": _w((lambda *s: torch.randn(*s, dtype=torch.bfloat16) * 0.05)(B, S, D)),
            "w1": _w((lambda *s: torch.randn(*s, dtype=torch.bfloat16) * 3.2)(D, F) * (D ** -0.5)),
            "b1": _w((lambda *s: torch.randn(*s, dtype=torch.bfloat16) * 3.2)(F) * 0.01),
            "w2": _w((lambda *s: torch.randn(*s, dtype=torch.bfloat16) * 0.4)(F, D) * (F ** -0.5)),
            "b2": _w((lambda *s: torch.randn(*s, dtype=torch.bfloat16) * 0.4)(D) * 0.01),
        }
    _B_in = _B_setup()

    return {
        "A_x": _A_in["x"],
        "A_wqkv": _A_in["wqkv"],
        "A_wo": _A_in["wo"],
        "B_x": _B_in["x"],
        "B_w1": _B_in["w1"],
        "B_b1": _B_in["b1"],
        "B_w2": _B_in["w2"],
        "B_b2": _B_in["b2"],
    }

def reference(A_x, A_wqkv, A_wo, B_x, B_w1, B_b1, B_w2, B_b2):
    def _A_ref(x, wqkv, wo):
        B, S, D = x.shape
        H = 32; Dh = D // H
        qkv = (lambda x, *d: x.permute(*d))((x @ wqkv).reshape(B, S, 3, H, Dh), 2, 0, 3, 1, 4)
        q, k, v = qkv[0], qkv[1], qkv[2]
        scale = Dh ** -0.5
        scores = torch.einsum("bhqd,bhkd->bhqk", q, k) * scale
        p = _softmax(scores, axis=-1)
        o = torch.einsum("bhqk,bhkd->bhqd", p, v)
        return (lambda x, *d: x.permute(*d))(o, 0, 2, 1, 3).reshape(B, S, D) @ wo

    def _B_ref(x, w1, b1, w2, b2):
        h = torch.einsum("bsd,df->bsf", x, w1) + b1
        h = _gelu(h)
        return torch.einsum("bsf,fd->bsd", h, w2) + b2

    x = A_x
    h = x + _A_ref(_layernorm(x, axis=-1), A_wqkv, A_wo)
    h2 = h + _B_ref(_layernorm(h, axis=-1), B_w1, B_b1, B_w2, B_b2)
    return h2
```

```asm
; @launch kernel=fused_kernel grid=(256,1,1) block=(512,1,1) lds=163840
.amdgcn_target "amdgcn-amd-amdhsa--gfx950"
.text
.globl fused_kernel
.p2align 8
.type fused_kernel,@function
fused_kernel:
    s_cmp_ge_u32 s2, 256
    s_cbranch_scc1 fused_kernel_exit
    s_load_dwordx2 s[4:5], s[0:1], 80
    v_lshrrev_b32 v1, 6, v0
    v_and_b32 v0, 63, v0
    s_nop 0
    v_readfirstlane_b32 s29, v1
    s_nop 1
    s_cmp_lg_u32 s29, 3
    s_cbranch_scc1 qkv_nc
    s_getpc_b64 s[54:55]
qkv_pc:
    s_lshr_b32 s3, s2, 3
    v_lshl_add_u32 v249, v0, 5, s3
    v_lshlrev_b32 v249, 7, v249
    v_min_u32 v249, fused_kernel_last-qkv_pc, v249
    v_mov_b32 v247, s55
    v_add_co_u32 v246, vcc, s54, v249
    s_nop 1
    v_addc_co_u32 v247, vcc, 0, v247, vcc
    global_load_dword v250, v[246:247], off
qkv_nc:
    s_mov_b32 s30, s29
    s_load_dwordx4 s[48:51], s[0:1], 0
    s_load_dwordx2 s[52:53], s[0:1], 72
    s_load_dwordx8 s[80:87], s[0:1], 32
    s_load_dwordx2 s[62:63], s[0:1], 16
    s_load_dwordx2 s[78:79], s[0:1], 64
    s_and_b32 s37, s2, 7
    s_lshr_b32 s38, s2, 3
    s_and_b32 s31, s37, 1
    s_lshl_b32 s31, s31, 3
    s_and_b32 s3, s38, 7
    s_add_u32 s31, s31, s3
    s_lshr_b32 s32, s37, 1
    s_lshl_b32 s32, s32, 2
    s_lshr_b32 s3, s38, 3
    s_add_u32 s32, s32, s3
    s_and_b32 s58, s31, 7
    s_lshl_b32 s58, s58, 1
    s_lshr_b32 s3, s31, 3
    s_add_u32 s58, s58, s3
    s_add_u32 s58, s58, s32
    s_and_b32 s58, s58, 15
    s_cmp_lt_u32 s30, 4
    s_cbranch_scc1 qkv_cons
    s_sub_u32 s30, s30, 4
    v_lshrrev_b32 v3, 3, v0
    v_and_b32 v4, 7, v0
    v_lshrrev_b32 v5, 1, v3
    v_xor_b32 v6, v4, v5
    v_lshlrev_b32 v7, 11, v3
    v_xor_b32 v1, 0, v6
    v_lshl_add_u32 v8, v1, 4, v7
    v_add_u32 v8, 0, v8
    v_xor_b32 v1, 4, v6
    v_lshl_add_u32 v9, v1, 4, v7
    v_add_u32 v9, 15360, v9
    v_xor_b32 v1, 0, v6
    v_lshl_add_u32 v10, v1, 4, v7
    v_add_u32 v10, 30720, v10
    v_xor_b32 v1, 4, v6
    v_lshl_add_u32 v11, v1, 4, v7
    v_add_u32 v11, 46080, v11
    v_and_b32 v5, 2, v3
    v_xor_b32 v6, v4, v5
    v_mul_u32_u24 v7, 6144, v3
    v_lshl_add_u32 v12, v6, 4, v7
    v_xor_b32 v6, 4, v6
    v_lshl_add_u32 v13, v6, 4, v7
    v_add_u32 v13, 48128, v13
    s_lshl_b32 s41, s30, 12
    s_lshl_b32 s42, s30, 11
    s_add_u32 s42, s42, 16384
    s_lshl_b32 s43, s31, 2
    s_add_u32 s43, s43, s30
    s_lshl_b32 s43, s43, 16
    s_mul_i32 s3, s30, 98304
    s_add_u32 s44, s32, 0
    s_and_b32 s44, s44, 15
    s_lshl_b32 s44, s44, 7
    s_add_u32 s44, s44, s3
    s_add_u32 s44, s44, 0
    s_add_u32 s45, s32, 0
    s_and_b32 s45, s45, 15
    s_lshl_b32 s45, s45, 7
    s_add_u32 s45, s45, s3
    s_add_u32 s45, s45, 2048
    s_add_u32 s46, s32, 0
    s_and_b32 s46, s46, 15
    s_lshl_b32 s46, s46, 7
    s_add_u32 s46, s46, s3
    s_add_u32 s46, s46, 4096
    s_mov_b32 s47, s58
    s_and_b32 s59, s2, 7
    s_mul_i32 s59, s59, 2
    s_and_b32 s3, s31, 3
    s_mul_i32 s3, s3, 0
    s_add_u32 s59, s59, s3
    s_and_b32 s59, s59, 15
    s_mov_b32 s33, 0
    s_waitcnt lgkmcnt(0)
    s_mov_b32 s8, s48
    s_mov_b32 s9, s49
    s_mov_b32 s10, 0x400000
    s_mov_b32 s11, 0x20000
    s_mov_b32 s12, s50
    s_mov_b32 s13, s51
    s_mov_b32 s14, 0x600000
    s_mov_b32 s15, 0x20000
    s_mov_b32 s34, 2
qkv_lpro:
    s_mul_i32 s36, s58, 393216
    s_lshl_b32 s35, s58, 7
    s_add_u32 s35, s35, s43
    s_add_u32 m0, s33, s41
    s_add_u32 s58, s59, 1
    s_add_u32 s54, s33, s41
    s_add_u32 s55, s33, s42
    s_add_u32 s78, s36, s44
    s_add_u32 s79, s36, s45
    s_add_u32 s80, s36, s46
    s_mov_b32 m0, s54
    s_nop 0
    buffer_load_dwordx4 v8, s[8:11], s35 offen offset:0 lds
    s_add_u32 m0, s55, 0
    s_nop 0
    buffer_load_dwordx4 v12, s[12:15], s78 offen offset:0 lds
    s_add_u32 m0, s55, 8192
    s_nop 0
    buffer_load_dwordx4 v12, s[12:15], s79 offen offset:0 lds
    s_mov_b32 m0, s54
    s_nop 0
    buffer_load_dwordx4 v9, s[8:11], s35 offen offset:1024 lds
    s_add_u32 m0, s55, 16384
    s_nop 0
    buffer_load_dwordx4 v12, s[12:15], s80 offen offset:0 lds
    s_add_u32 m0, s55, 0
    s_nop 0
    buffer_load_dwordx4 v13, s[12:15], s78 offen offset:1024 lds
    s_mov_b32 m0, s54
    s_nop 0
    buffer_load_dwordx4 v10, s[8:11], s35 offen offset:2048 lds
    s_add_u32 m0, s55, 8192
    s_nop 0
    buffer_load_dwordx4 v13, s[12:15], s79 offen offset:1024 lds
    s_mov_b32 m0, s54
    s_nop 0
    buffer_load_dwordx4 v11, s[8:11], s35 offen offset:3072 lds
    s_add_u32 m0, s55, 16384
    s_nop 0
    buffer_load_dwordx4 v13, s[12:15], s80 offen offset:1024 lds
    s_and_b32 s58, s58, 15
    s_cmp_eq_u32 s59, s47
    s_cselect_b32 s58, s58, s59
    s_add_u32 s59, s58, 1
    s_and_b32 s59, s59, 15
    s_add_u32 s33, s33, 40960
    s_cmp_ge_u32 s33, 163840
    s_cselect_b32 s33, 0, s33
    s_sub_u32 s34, s34, 1
    s_cmp_lg_u32 s34, 0
    s_cbranch_scc1 qkv_lpro
    s_waitcnt vmcnt(10)
    s_barrier
    s_mul_i32 s36, s58, 393216
    s_lshl_b32 s35, s58, 7
    s_add_u32 s35, s35, s43
    s_add_u32 m0, s33, s41
    s_add_u32 s58, s59, 1
    s_add_u32 s54, s33, s41
    s_add_u32 s55, s33, s42
    s_add_u32 s78, s36, s44
    s_add_u32 s79, s36, s45
    s_add_u32 s80, s36, s46
    s_mov_b32 m0, s54
    s_nop 0
    buffer_load_dwordx4 v8, s[8:11], s35 offen offset:0 lds
    s_add_u32 m0, s55, 0
    s_nop 0
    buffer_load_dwordx4 v12, s[12:15], s78 offen offset:0 lds
    s_add_u32 m0, s55, 8192
    s_nop 0
    buffer_load_dwordx4 v12, s[12:15], s79 offen offset:0 lds
    s_mov_b32 m0, s54
    s_nop 0
    buffer_load_dwordx4 v9, s[8:11], s35 offen offset:1024 lds
    s_add_u32 m0, s55, 16384
    s_nop 0
    buffer_load_dwordx4 v12, s[12:15], s80 offen offset:0 lds
    s_add_u32 m0, s55, 0
    s_nop 0
    buffer_load_dwordx4 v13, s[12:15], s78 offen offset:1024 lds
    s_mov_b32 m0, s54
    s_nop 0
    buffer_load_dwordx4 v10, s[8:11], s35 offen offset:2048 lds
    s_add_u32 m0, s55, 8192
    s_nop 0
    buffer_load_dwordx4 v13, s[12:15], s79 offen offset:1024 lds
    s_mov_b32 m0, s54
    s_nop 0
    buffer_load_dwordx4 v11, s[8:11], s35 offen offset:3072 lds
    s_add_u32 m0, s55, 16384
    s_nop 0
    buffer_load_dwordx4 v13, s[12:15], s80 offen offset:1024 lds
    s_and_b32 s58, s58, 15
    s_cmp_eq_u32 s59, s47
    s_cselect_b32 s58, s58, s59
    s_add_u32 s59, s58, 1
    s_and_b32 s59, s59, 15
    s_add_u32 s33, s33, 40960
    s_cmp_ge_u32 s33, 163840
    s_cselect_b32 s33, 0, s33
    s_mul_i32 s36, s58, 393216
    s_lshl_b32 s35, s58, 7
    s_add_u32 s35, s35, s43
    s_add_u32 m0, s33, s41
    s_add_u32 s58, s59, 1
    s_add_u32 s54, s33, s41
    s_add_u32 s55, s33, s42
    s_add_u32 s78, s36, s44
    s_add_u32 s79, s36, s45
    s_add_u32 s80, s36, s46
    s_mov_b32 m0, s54
    s_nop 0
    buffer_load_dwordx4 v8, s[8:11], s35 offen offset:0 lds
    s_add_u32 m0, s55, 0
    s_nop 0
    buffer_load_dwordx4 v12, s[12:15], s78 offen offset:0 lds
    s_add_u32 m0, s55, 8192
    s_nop 0
    buffer_load_dwordx4 v12, s[12:15], s79 offen offset:0 lds
    s_mov_b32 m0, s54
    s_nop 0
    buffer_load_dwordx4 v9, s[8:11], s35 offen offset:1024 lds
    s_add_u32 m0, s55, 16384
    s_nop 0
    buffer_load_dwordx4 v12, s[12:15], s80 offen offset:0 lds
    s_add_u32 m0, s55, 0
    s_nop 0
    buffer_load_dwordx4 v13, s[12:15], s78 offen offset:1024 lds
    s_mov_b32 m0, s54
    s_nop 0
    buffer_load_dwordx4 v10, s[8:11], s35 offen offset:2048 lds
    s_add_u32 m0, s55, 8192
    s_nop 0
    buffer_load_dwordx4 v13, s[12:15], s79 offen offset:1024 lds
    s_mov_b32 m0, s54
    s_nop 0
    buffer_load_dwordx4 v11, s[8:11], s35 offen offset:3072 lds
    s_add_u32 m0, s55, 16384
    s_nop 0
    buffer_load_dwordx4 v13, s[12:15], s80 offen offset:1024 lds
    s_and_b32 s58, s58, 15
    s_cmp_eq_u32 s59, s47
    s_cselect_b32 s58, s58, s59
    s_add_u32 s59, s58, 1
    s_and_b32 s59, s59, 15
    s_add_u32 s33, s33, 40960
    s_cmp_ge_u32 s33, 163840
    s_cselect_b32 s33, 0, s33
    s_mov_b32 s34, 12
qkv_lloop:
    s_waitcnt vmcnt(20)
    s_barrier
    s_mul_i32 s36, s58, 393216
    s_lshl_b32 s35, s58, 7
    s_add_u32 s35, s35, s43
    s_add_u32 m0, s33, s41
    s_add_u32 s58, s59, 1
    s_add_u32 s54, s33, s41
    s_add_u32 s55, s33, s42
    s_add_u32 s78, s36, s44
    s_add_u32 s79, s36, s45
    s_add_u32 s80, s36, s46
    s_mov_b32 m0, s54
    s_nop 0
    buffer_load_dwordx4 v8, s[8:11], s35 offen offset:0 lds
    s_add_u32 m0, s55, 0
    s_nop 0
    buffer_load_dwordx4 v12, s[12:15], s78 offen offset:0 lds
    s_add_u32 m0, s55, 8192
    s_nop 0
    buffer_load_dwordx4 v12, s[12:15], s79 offen offset:0 lds
    s_mov_b32 m0, s54
    s_nop 0
    buffer_load_dwordx4 v9, s[8:11], s35 offen offset:1024 lds
    s_add_u32 m0, s55, 16384
    s_nop 0
    buffer_load_dwordx4 v12, s[12:15], s80 offen offset:0 lds
    s_add_u32 m0, s55, 0
    s_nop 0
    buffer_load_dwordx4 v13, s[12:15], s78 offen offset:1024 lds
    s_mov_b32 m0, s54
    s_nop 0
    buffer_load_dwordx4 v10, s[8:11], s35 offen offset:2048 lds
    s_add_u32 m0, s55, 8192
    s_nop 0
    buffer_load_dwordx4 v13, s[12:15], s79 offen offset:1024 lds
    s_mov_b32 m0, s54
    s_nop 0
    buffer_load_dwordx4 v11, s[8:11], s35 offen offset:3072 lds
    s_add_u32 m0, s55, 16384
    s_nop 0
    buffer_load_dwordx4 v13, s[12:15], s80 offen offset:1024 lds
    s_and_b32 s58, s58, 15
    s_cmp_eq_u32 s59, s47
    s_cselect_b32 s58, s58, s59
    s_add_u32 s59, s58, 1
    s_and_b32 s59, s59, 15
    s_add_u32 s33, s33, 40960
    s_cmp_ge_u32 s33, 163840
    s_cselect_b32 s33, 0, s33
    s_sub_u32 s34, s34, 1
    s_cmp_lg_u32 s34, 0
    s_cbranch_scc1 qkv_lloop
    s_waitcnt vmcnt(20)
    s_barrier
    s_mov_b32 s88, s52
    s_mov_b32 s89, s53
    s_mov_b32 s90, 0x100
    s_mov_b32 s91, 0x20000
    s_mov_b32 s43, 0
    v_min_u32 v244, 3, v0
    v_lshlrev_b32 v244, 6, v244
    s_mov_b32 s87, 0x40000
    s_mov_b32 s86, 0x40
qkv_pld:
    buffer_load_dword v240, v244, s[88:91], s43 offen sc1
    s_waitcnt vmcnt(0)
    v_cmp_ne_u32 vcc, s86, v240
    s_sub_u32 s87, s87, 1
    s_nop 3
    s_cbranch_vccz qkv_pdd
    s_sleep 6
    s_cmp_lg_u32 s87, 0
    s_cbranch_scc1 qkv_pld
qkv_pdd:
    s_mov_b32 s20, s4
    s_mov_b32 s21, s5
    s_mov_b32 s22, 0x200000
    s_mov_b32 s23, 0x20000
    s_and_b32 s3, s30, 1
    s_lshl_b32 s3, s3, 6
    v_add_u32 v20, s3, v0
    s_add_u32 s44, s32, 64
    s_cmp_lt_u32 s30, 2
    s_cselect_b32 s43, s31, s44
    s_lshl_b32 s43, s43, 14
    v_lshlrev_b32 v21, 3, v20
    buffer_load_dwordx2 v[24:25], v21, s[20:23], s43 offen sc1
    s_add_u32 s43, s43, 1024
    buffer_load_dwordx2 v[26:27], v21, s[20:23], s43 offen sc1
    s_add_u32 s43, s43, 1024
    buffer_load_dwordx2 v[28:29], v21, s[20:23], s43 offen sc1
    s_add_u32 s43, s43, 1024
    buffer_load_dwordx2 v[30:31], v21, s[20:23], s43 offen sc1
    s_add_u32 s43, s43, 1024
    buffer_load_dwordx2 v[32:33], v21, s[20:23], s43 offen sc1
    s_add_u32 s43, s43, 1024
    buffer_load_dwordx2 v[34:35], v21, s[20:23], s43 offen sc1
    s_add_u32 s43, s43, 1024
    buffer_load_dwordx2 v[36:37], v21, s[20:23], s43 offen sc1
    s_add_u32 s43, s43, 1024
    buffer_load_dwordx2 v[38:39], v21, s[20:23], s43 offen sc1
    s_add_u32 s43, s43, 1024
    buffer_load_dwordx2 v[40:41], v21, s[20:23], s43 offen sc1
    s_add_u32 s43, s43, 1024
    buffer_load_dwordx2 v[42:43], v21, s[20:23], s43 offen sc1
    s_add_u32 s43, s43, 1024
    buffer_load_dwordx2 v[44:45], v21, s[20:23], s43 offen sc1
    s_add_u32 s43, s43, 1024
    buffer_load_dwordx2 v[46:47], v21, s[20:23], s43 offen sc1
    s_add_u32 s43, s43, 1024
    buffer_load_dwordx2 v[48:49], v21, s[20:23], s43 offen sc1
    s_add_u32 s43, s43, 1024
    buffer_load_dwordx2 v[50:51], v21, s[20:23], s43 offen sc1
    s_add_u32 s43, s43, 1024
    buffer_load_dwordx2 v[52:53], v21, s[20:23], s43 offen sc1
    s_add_u32 s43, s43, 1024
    buffer_load_dwordx2 v[54:55], v21, s[20:23], s43 offen sc1
    s_add_u32 s43, s43, 1024
    s_mov_b32 s8, s62
    s_mov_b32 s9, s63
    s_mov_b32 s10, 0x200000
    s_mov_b32 s11, 0x20000
    s_add_u32 s12, s4, 0x3200000
    s_addc_u32 s13, s5, 0
    s_mov_b32 s14, 0x200000
    s_mov_b32 s15, 0x20000
    s_mov_b32 s35, 2048
    v_lshrrev_b32 v8, 2, v0
    v_mul_lo_u32 v8, s35, v8
    v_and_b32 v7, 3, v0
    v_lshl_add_u32 v8, v7, 4, v8
    v_lshlrev_b32 v9, 4, v7
    v_bfe_u32 v7, v0, 2, 2
    v_lshl_add_u32 v9, v7, 6, v9
    s_lshr_b32 s41, s2, 3
    s_and_b32 s42, s2, 7
    s_lshl_b32 s42, s42, 2
    s_add_u32 s42, s42, s30
    s_lshl_b32 s43, s41, 16
    s_lshl_b32 s3, s42, 6
    s_add_u32 s43, s43, s3
    s_add_u32 s44, s43, 32768
    s_lshl_b32 s45, s30, 11
    s_add_u32 s45, s45, 8192
    s_mov_b32 m0, s45
    v_lshrrev_b32 v7, 4, v0
    buffer_load_dwordx4 v8, s[8:11], s43 offen nt lds
    s_add_u32 m0, s45, 1024
    v_lshl_add_u32 v9, v7, 9, v9
    buffer_load_dwordx4 v8, s[8:11], s44 offen nt lds
    v_add_u32 v9, s45, v9
    v_lshlrev_b32 v10, 4, v0
    s_barrier
    s_barrier
    s_waitcnt vmcnt(2)
    v_pk_add_f32 v[24:25], v[24:25], v[26:27]
    v_pk_add_f32 v[24:25], v[24:25], v[28:29]
    v_pk_add_f32 v[24:25], v[24:25], v[30:31]
    v_pk_add_f32 v[24:25], v[24:25], v[32:33]
    v_pk_add_f32 v[24:25], v[24:25], v[34:35]
    v_pk_add_f32 v[24:25], v[24:25], v[36:37]
    v_pk_add_f32 v[24:25], v[24:25], v[38:39]
    v_pk_add_f32 v[24:25], v[24:25], v[40:41]
    v_pk_add_f32 v[24:25], v[24:25], v[42:43]
    v_pk_add_f32 v[24:25], v[24:25], v[44:45]
    v_pk_add_f32 v[24:25], v[24:25], v[46:47]
    v_pk_add_f32 v[24:25], v[24:25], v[48:49]
    v_pk_add_f32 v[24:25], v[24:25], v[50:51]
    v_pk_add_f32 v[24:25], v[24:25], v[52:53]
    v_pk_add_f32 v[24:25], v[24:25], v[54:55]
    s_cmp_lt_u32 s30, 2
    s_cbranch_scc1 qkv_rows2
    ds_write_b64 v21, v[24:25] offset:1024
    s_branch qkv_rc2
qkv_rows2:
    v_mul_f32 v24, 0xba800000, v24
    v_mul_f32 v25, 0x3a800000, v25
    v_fma_f32 v25, -v24, v24, v25
    v_max_f32 v25, 0, v25
    v_add_f32 v25, 0x3727c5ac, v25
    v_rsq_f32 v26, v25
    v_lshlrev_b32 v21, 2, v20
    ds_write_b32 v21, v24
    ds_write_b32 v21, v26 offset:512
qkv_rc2:
    s_waitcnt lgkmcnt(0)
    s_barrier
    s_lshr_b32 s43, s42, 1
    s_lshl_b32 s43, s43, 17
    s_and_b32 s3, s42, 1
    s_lshl_b32 s3, s3, 12
    s_add_u32 s43, s43, s3
    s_lshr_b32 s3, s41, 1
    s_lshl_b32 s3, s3, 13
    s_add_u32 s43, s43, s3
    s_and_b32 s3, s41, 1
    s_lshl_b32 s3, s3, 10
    s_add_u32 s43, s43, s3
    s_waitcnt vmcnt(0)
    ds_read_b64_tr_b16 v[12:13], v9 offset:0
    ds_read_b64_tr_b16 v[14:15], v9 offset:256
    ds_read_b64_tr_b16 v[16:17], v9 offset:8
    ds_read_b64_tr_b16 v[18:19], v9 offset:264
    s_waitcnt lgkmcnt(0)
    buffer_store_dwordx4 v[12:15], v10, s[12:15], s43 offen offset:0 sc1
    buffer_store_dwordx4 v[16:19], v10, s[12:15], s43 offen offset:2048 sc1
    s_branch qkv_end
qkv_cons:
    s_lshr_b32 s39, s30, 1
    s_and_b32 s40, s30, 1
    v_and_b32 v1, 15, v0
    v_lshrrev_b32 v10, 4, v0
    v_lshrrev_b32 v11, 1, v1
    v_xor_b32 v11, v11, v10
    v_lshlrev_b32 v6, 7, v1
    v_lshl_add_u32 v6, v11, 4, v6
    s_lshl_b32 s3, s39, 13
    v_add_u32 v6, s3, v6
    v_xor_b32 v7, 64, v6
    v_bfe_u32 v11, v0, 3, 2
    s_lshl_b32 s3, s40, 1
    v_xor_b32 v11, s3, v11
    v_lshlrev_b32 v8, 5, v11
    v_lshl_add_u32 v8, v10, 10, v8
    v_bfe_u32 v11, v0, 2, 2
    v_lshl_add_u32 v8, v11, 7, v8
    v_and_b32 v11, 3, v0
    v_lshl_add_u32 v8, v11, 3, v8
    v_add_u32 v8, 16384, v8
    v_xor_b32 v9, 32, v8
    v_mov_b32 v2, v6
    v_mov_b32 v4, v8
    v_mov_b32 v3, v7
    v_mov_b32 v5, v9
    v_mov_b32 v12, 0
    v_mov_b32 v13, 0
    v_mov_b32 v14, 0
    v_mov_b32 v15, 0
    v_mov_b32 v16, 0
    v_mov_b32 v17, 0
    v_mov_b32 v18, 0
    v_mov_b32 v19, 0
    v_mov_b32 v20, 0
    v_mov_b32 v21, 0
    v_mov_b32 v22, 0
    v_mov_b32 v23, 0
    v_mov_b32 v24, 0
    v_mov_b32 v25, 0
    v_mov_b32 v26, 0
    v_mov_b32 v27, 0
    v_mov_b32 v28, 0
    v_mov_b32 v29, 0
    v_mov_b32 v30, 0
    v_mov_b32 v31, 0
    v_mov_b32 v32, 0
    v_mov_b32 v33, 0
    v_mov_b32 v34, 0
    v_mov_b32 v35, 0
    v_mov_b32 v36, 0
    v_mov_b32 v37, 0
    v_mov_b32 v38, 0
    v_mov_b32 v39, 0
    v_mov_b32 v40, 0
    v_mov_b32 v41, 0
    v_mov_b32 v42, 0
    v_mov_b32 v43, 0
    v_mov_b32 v44, 0
    v_mov_b32 v45, 0
    v_mov_b32 v46, 0
    v_mov_b32 v47, 0
    v_mov_b32 v48, 0
    v_mov_b32 v49, 0
    v_mov_b32 v50, 0
    v_mov_b32 v51, 0
    v_mov_b32 v52, 0
    v_mov_b32 v53, 0
    v_mov_b32 v54, 0
    v_mov_b32 v55, 0
    v_mov_b32 v56, 0
    v_mov_b32 v57, 0
    v_mov_b32 v58, 0
    v_mov_b32 v59, 0
    v_mov_b32 v60, 0
    v_mov_b32 v61, 0
    v_mov_b32 v62, 0
    v_mov_b32 v63, 0
    v_mov_b32 v64, 0
    v_mov_b32 v65, 0
    v_mov_b32 v66, 0
    v_mov_b32 v67, 0
    v_mov_b32 v68, 0
    v_mov_b32 v69, 0
    v_mov_b32 v70, 0
    v_mov_b32 v71, 0
    v_mov_b32 v72, 0
    v_mov_b32 v73, 0
    v_mov_b32 v74, 0
    v_mov_b32 v75, 0
    v_mov_b32 v76, 0
    v_mov_b32 v77, 0
    v_mov_b32 v78, 0
    v_mov_b32 v79, 0
    v_mov_b32 v80, 0
    v_mov_b32 v81, 0
    v_mov_b32 v82, 0
    v_mov_b32 v83, 0
    v_mov_b32 v84, 0
    v_mov_b32 v85, 0
    v_mov_b32 v86, 0
    v_mov_b32 v87, 0
    v_mov_b32 v88, 0
    v_mov_b32 v89, 0
    v_mov_b32 v90, 0
    v_mov_b32 v91, 0
    v_mov_b32 v92, 0
    v_mov_b32 v93, 0
    v_mov_b32 v94, 0
    v_mov_b32 v95, 0
    v_mov_b32 v96, 0
    v_mov_b32 v97, 0
    v_mov_b32 v98, 0
    v_mov_b32 v99, 0
    v_mov_b32 v100, 0
    v_mov_b32 v101, 0
    v_mov_b32 v102, 0
    v_mov_b32 v103, 0
    v_mov_b32 v104, 0
    v_mov_b32 v105, 0
    v_mov_b32 v106, 0
    v_mov_b32 v107, 0
    s_mov_b32 s33, 0
    s_mov_b32 s34, 16
    s_waitcnt lgkmcnt(0)
    s_add_u32 s88, s4, 0x4400000
    s_addc_u32 s89, s5, 0
    s_mov_b32 s90, 0xe1400
    s_mov_b32 s91, 0x20000
    s_lshl_b32 s3, s2, 2
    s_add_u32 s3, s3, s30
    s_lshl_b32 s3, s3, 10
    v_lshlrev_b32 v11, 4, v0
    buffer_store_dwordx4 v[12:15], v11, s[88:91], s3 offen sc1
    s_lshr_b32 s3, s2, 3
    v_lshlrev_b32 v248, 5, v0
    v_add_u32 v248, s3, v248
    v_lshlrev_b32 v249, 21, v248
    s_cmp_lg_u32 s30, 0
    s_cbranch_scc1 qkv_w0
    s_mov_b32 s44, s4
    s_mov_b32 s45, s5
    s_mov_b32 s46, 0x4d00000
    s_mov_b32 s47, 0x20000
    buffer_load_dword v250, v249, s[44:47], 0 offen sc1
    s_mov_b32 s44, s52
    s_mov_b32 s45, s53
    s_mov_b32 s46, 0x100
    s_mov_b32 s47, 0x20000
    buffer_load_dword v250, v249, s[44:47], 0 offen sc1
qkv_w0:
    s_cmp_lg_u32 s30, 1
    s_cbranch_scc1 qkv_w1
    s_mov_b32 s44, s80
    s_mov_b32 s45, s81
    s_mov_b32 s46, 0x700000
    s_mov_b32 s47, 0x20000
    buffer_load_dword v250, v249, s[44:47], 0 offen sc1
    s_mov_b32 s44, s84
    s_mov_b32 s45, s85
    s_mov_b32 s46, 0x700000
    s_mov_b32 s47, 0x20000
    buffer_load_dword v250, v249, s[44:47], 0 offen sc1
    s_mov_b32 s44, s62
    s_mov_b32 s45, s63
    s_mov_b32 s46, 0x200000
    s_mov_b32 s47, 0x20000
    buffer_load_dword v250, v249, s[44:47], 0 offen sc1
qkv_w1:
    s_cmp_lg_u32 s30, 2
    s_cbranch_scc1 qkv_w2
    s_mov_b32 s44, s78
    s_mov_b32 s45, s79
    s_mov_b32 s46, 0x400000
    s_mov_b32 s47, 0x20000
    buffer_load_dword v250, v249, s[44:47], 0 offen sc1
    s_mov_b32 s44, s48
    s_mov_b32 s45, s49
    s_mov_b32 s46, 0x400000
    s_mov_b32 s47, 0x20000
    buffer_load_dword v250, v249, s[44:47], 0 offen sc1
    s_mov_b32 s44, s50
    s_mov_b32 s45, s51
    s_mov_b32 s46, 0x600000
    s_mov_b32 s47, 0x20000
    buffer_load_dword v250, v249, s[44:47], 0 offen sc1
qkv_w2:
    s_cmp_lg_u32 s30, 3
    s_cbranch_scc1 qkv_w3
    v_lshlrev_b32 v249, 7, v248
    s_mov_b32 s44, s82
    s_mov_b32 s45, s83
    s_mov_b32 s46, 0x1c00
    s_mov_b32 s47, 0x20000
    buffer_load_dword v250, v249, s[44:47], 0 offen
    s_mov_b32 s44, s86
    s_mov_b32 s45, s87
    s_mov_b32 s46, 0x800
    s_mov_b32 s47, 0x20000
    buffer_load_dword v250, v249, s[44:47], 0 offen
qkv_w3:
    v_mov_b32 v190, 0x3f803f80
    v_mov_b32 v191, 0x3f803f80
    v_mov_b32 v192, 0x3f803f80
    v_mov_b32 v193, 0x3f803f80
    s_mov_b32 s20, s4
    s_mov_b32 s21, s5
    s_mov_b32 s22, 0x200000
    s_mov_b32 s23, 0x20000
    s_mov_b32 s24, s52
    s_mov_b32 s25, s53
    s_mov_b32 s26, 0x100
    s_mov_b32 s27, 0x20000
    s_lshl_b32 s3, s40, 12
    v_add_u32 v240, s3, v6
    v_add_u32 v241, s3, v7
    s_cmp_eq_u32 s39, 0
    s_cselect_b64 vcc, -1, 0
    v_add_u32 v242, 8192, v9
    v_add_u32 v243, 16384, v8
    v_add_u32 v244, 16384, v9
    v_add_u32 v245, 8192, v8
    v_cndmask_b32 v242, v242, v8, vcc
    v_cndmask_b32 v243, v243, v9, vcc
    v_cndmask_b32 v244, v244, v245, vcc
    s_lshl_b32 s41, s31, 4
    s_add_u32 s41, s41, s58
    s_lshl_b32 s41, s41, 10
    s_lshl_b32 s3, s30, 8
    s_add_u32 s41, s41, s3
    s_lshl_b32 s42, s32, 4
    s_add_u32 s42, s42, s58
    s_lshl_b32 s42, s42, 10
    s_lshl_b32 s3, s40, 9
    s_add_u32 s42, s42, s3
    s_lshl_b32 s3, s39, 8
    s_add_u32 s42, s42, s3
    s_add_u32 s42, s42, 1048576
    v_lshlrev_b32 v246, 3, v1
    v_lshlrev_b32 v247, 4, v10
    v_and_b32 v11, 3, v0
    v_lshl_add_u32 v247, v11, 6, v247
    v_cmp_eq_u32 s[54:55], 1, v11
    v_cmp_eq_u32 s[56:57], 2, v11
    v_cmp_eq_u32 s[60:61], 3, v11
    s_barrier
    ds_read_b128 v[108:111], v240 offset:0
    ds_read_b128 v[112:115], v240 offset:2048
    ds_read_b64_tr_b16 v[116:117], v242 offset:0
    ds_read_b64_tr_b16 v[118:119], v242 offset:512
    ds_read_b64_tr_b16 v[120:121], v243 offset:0
    ds_read_b64_tr_b16 v[122:123], v243 offset:512
    ds_read_b64_tr_b16 v[124:125], v244 offset:0
    ds_read_b64_tr_b16 v[126:127], v244 offset:512
    ds_read_b128 v[128:131], v241 offset:0
    ds_read_b128 v[132:135], v241 offset:2048
    ds_read_b64_tr_b16 v[136:137], v242 offset:4096
    ds_read_b64_tr_b16 v[138:139], v242 offset:4608
    ds_read_b64_tr_b16 v[140:141], v243 offset:4096
    ds_read_b64_tr_b16 v[142:143], v243 offset:4608
    ds_read_b64_tr_b16 v[144:145], v244 offset:4096
    ds_read_b64_tr_b16 v[146:147], v244 offset:4608
    s_waitcnt lgkmcnt(8)
    v_mfma_f32_16x16x32_bf16 v[196:199], v[190:193], v[108:111], 0
    v_mfma_f32_16x16x32_bf16 v[200:203], v[108:111], v[108:111], 0
    v_mfma_f32_16x16x32_bf16 v[204:207], v[190:193], v[112:115], 0
    v_mfma_f32_16x16x32_bf16 v[208:211], v[112:115], v[112:115], 0
    v_mfma_f32_16x16x32_bf16 v[212:215], v[116:119], v[190:193], 0
    v_mfma_f32_16x16x32_bf16 v[216:219], v[120:123], v[190:193], 0
    v_mfma_f32_16x16x32_bf16 v[220:223], v[124:127], v[190:193], 0
    s_waitcnt lgkmcnt(0)
    v_mfma_f32_16x16x32_bf16 v[196:199], v[190:193], v[128:131], v[196:199]
    v_mfma_f32_16x16x32_bf16 v[200:203], v[128:131], v[128:131], v[200:203]
    v_mfma_f32_16x16x32_bf16 v[204:207], v[190:193], v[132:135], v[204:207]
    v_mfma_f32_16x16x32_bf16 v[208:211], v[132:135], v[132:135], v[208:211]
    v_mfma_f32_16x16x32_bf16 v[212:215], v[136:139], v[190:193], v[212:215]
    v_mfma_f32_16x16x32_bf16 v[216:219], v[140:143], v[190:193], v[216:219]
    v_mfma_f32_16x16x32_bf16 v[220:223], v[144:147], v[190:193], v[220:223]
    ds_read_b64_tr_b16 v[124:125], v4 offset:0
    ds_read_b64_tr_b16 v[126:127], v4 offset:512
    ds_read_b128 v[108:111], v2 offset:0
    ds_read_b128 v[112:115], v2 offset:2048
    ds_read_b128 v[116:119], v2 offset:4096
    ds_read_b128 v[120:123], v2 offset:6144
    ds_read_b64_tr_b16 v[128:129], v5 offset:0
    ds_read_b64_tr_b16 v[130:131], v5 offset:512
    ds_read_b64_tr_b16 v[132:133], v4 offset:8192
    ds_read_b64_tr_b16 v[134:135], v4 offset:8704
    ds_read_b64_tr_b16 v[136:137], v5 offset:8192
    ds_read_b64_tr_b16 v[138:139], v5 offset:8704
    ds_read_b64_tr_b16 v[140:141], v4 offset:16384
    ds_read_b64_tr_b16 v[142:143], v4 offset:16896
    ds_read_b64_tr_b16 v[144:145], v5 offset:16384
    ds_read_b64_tr_b16 v[146:147], v5 offset:16896
    v_cndmask_b32 v197, v200, v201, s[54:55]
    v_cndmask_b32 v197, v197, v202, s[56:57]
    v_cndmask_b32 v197, v197, v203, s[60:61]
    v_cndmask_b32 v205, v208, v209, s[54:55]
    v_cndmask_b32 v205, v205, v210, s[56:57]
    v_cndmask_b32 v205, v205, v211, s[60:61]
    v_cndmask_b32 v212, v212, v216, s[54:55]
    v_cndmask_b32 v212, v212, v220, s[56:57]
    v_cndmask_b32 v213, v213, v217, s[54:55]
    v_cndmask_b32 v213, v213, v221, s[56:57]
    v_cndmask_b32 v214, v214, v218, s[54:55]
    v_cndmask_b32 v214, v214, v222, s[56:57]
    v_cndmask_b32 v215, v215, v219, s[54:55]
    v_cndmask_b32 v215, v215, v223, s[56:57]
    s_mov_b32 exec_lo, 0x00f0000f
    s_mov_b32 exec_hi, 0xf0000f00
    buffer_store_dwordx2 v[196:197], v246, s[20:23], s41 offen offset:0 sc1
    buffer_store_dwordx2 v[204:205], v246, s[20:23], s41 offen offset:128 sc1
    buffer_store_dwordx4 v[212:215], v247, s[20:23], s42 offen sc1
    s_mov_b64 exec, -1
.p2align 3
qkv_cloop:
    s_sub_u32 s3, s34, 12
    s_cmp_lt_u32 s3, 4
    s_cbranch_scc1 qkv_aux
qkv_auxd:
    s_waitcnt lgkmcnt(13)
    v_mfma_f32_16x16x32_bf16 v[12:15], v[124:127], v[108:111], v[12:15]
    ds_read_b64_tr_b16 v[164:165], v4 offset:4096
    s_waitcnt lgkmcnt(13)
    v_mfma_f32_16x16x32_bf16 v[36:39], v[124:127], v[112:115], v[36:39]
    ds_read_b64_tr_b16 v[166:167], v4 offset:4608
    s_waitcnt lgkmcnt(13)
    v_mfma_f32_16x16x32_bf16 v[60:63], v[124:127], v[116:119], v[60:63]
    ds_read_b128 v[148:151], v3 offset:0
    s_waitcnt lgkmcnt(13)
    v_mfma_f32_16x16x32_bf16 v[84:87], v[124:127], v[120:123], v[84:87]
    ds_read_b128 v[152:155], v3 offset:2048
    s_waitcnt lgkmcnt(12)
    v_mfma_f32_16x16x32_bf16 v[16:19], v[128:131], v[108:111], v[16:19]
    ds_read_b128 v[156:159], v3 offset:4096
    v_mfma_f32_16x16x32_bf16 v[40:43], v[128:131], v[112:115], v[40:43]
    ds_read_b128 v[160:163], v3 offset:6144
    v_mfma_f32_16x16x32_bf16 v[64:67], v[128:131], v[116:119], v[64:67]
    ds_read_b64_tr_b16 v[168:169], v5 offset:4096
    v_mfma_f32_16x16x32_bf16 v[88:91], v[128:131], v[120:123], v[88:91]
    ds_read_b64_tr_b16 v[170:171], v5 offset:4608
    s_waitcnt lgkmcnt(14)
    v_mfma_f32_16x16x32_bf16 v[20:23], v[132:135], v[108:111], v[20:23]
    ds_read_b64_tr_b16 v[172:173], v4 offset:12288
    v_mfma_f32_16x16x32_bf16 v[44:47], v[132:135], v[112:115], v[44:47]
    ds_read_b64_tr_b16 v[174:175], v4 offset:12800
    v_mfma_f32_16x16x32_bf16 v[68:71], v[132:135], v[116:119], v[68:71]
    ds_read_b64_tr_b16 v[176:177], v5 offset:12288
    v_mfma_f32_16x16x32_bf16 v[92:95], v[132:135], v[120:123], v[92:95]
    ds_read_b64_tr_b16 v[178:179], v5 offset:12800
    s_waitcnt lgkmcnt(15)
    v_mfma_f32_16x16x32_bf16 v[24:27], v[136:139], v[108:111], v[24:27]
    ds_read_b64_tr_b16 v[180:181], v4 offset:20480
    v_mfma_f32_16x16x32_bf16 v[48:51], v[136:139], v[112:115], v[48:51]
    ds_read_b64_tr_b16 v[182:183], v4 offset:20992
    v_mfma_f32_16x16x32_bf16 v[72:75], v[136:139], v[116:119], v[72:75]
    ds_read_b64_tr_b16 v[184:185], v5 offset:20480
    v_mfma_f32_16x16x32_bf16 v[96:99], v[136:139], v[120:123], v[96:99]
    ds_read_b64_tr_b16 v[186:187], v5 offset:20992
    s_waitcnt lgkmcnt(15)
    v_mfma_f32_16x16x32_bf16 v[28:31], v[108:111], v[140:143], v[28:31]
    v_mfma_f32_16x16x32_bf16 v[52:55], v[112:115], v[140:143], v[52:55]
    v_mfma_f32_16x16x32_bf16 v[76:79], v[116:119], v[140:143], v[76:79]
    v_mfma_f32_16x16x32_bf16 v[100:103], v[120:123], v[140:143], v[100:103]
    v_mfma_f32_16x16x32_bf16 v[32:35], v[108:111], v[144:147], v[32:35]
    v_mfma_f32_16x16x32_bf16 v[56:59], v[112:115], v[144:147], v[56:59]
    v_mfma_f32_16x16x32_bf16 v[80:83], v[116:119], v[144:147], v[80:83]
    v_mfma_f32_16x16x32_bf16 v[104:107], v[120:123], v[144:147], v[104:107]
    s_waitcnt lgkmcnt(13)
    v_mfma_f32_16x16x32_bf16 v[12:15], v[164:167], v[148:151], v[12:15]
    s_add_u32 s33, s33, 40960
    s_cmp_ge_u32 s33, 163840
    s_cselect_b32 s33, 0, s33
    v_add_u32 v2, s33, v6
    v_add_u32 v3, s33, v7
    s_waitcnt lgkmcnt(12)
    v_mfma_f32_16x16x32_bf16 v[36:39], v[164:167], v[152:155], v[36:39]
    s_waitcnt lgkmcnt(11)
    v_mfma_f32_16x16x32_bf16 v[60:63], v[164:167], v[156:159], v[60:63]
    v_add_u32 v4, s33, v8
    v_add_u32 v5, s33, v9
    s_waitcnt lgkmcnt(0)
    s_barrier
    ds_read_b64_tr_b16 v[124:125], v4 offset:0
    v_mfma_f32_16x16x32_bf16 v[84:87], v[164:167], v[160:163], v[84:87]
    ds_read_b64_tr_b16 v[126:127], v4 offset:512
    v_mfma_f32_16x16x32_bf16 v[16:19], v[168:171], v[148:151], v[16:19]
    ds_read_b128 v[108:111], v2 offset:0
    v_mfma_f32_16x16x32_bf16 v[40:43], v[168:171], v[152:155], v[40:43]
    ds_read_b128 v[112:115], v2 offset:2048
    v_mfma_f32_16x16x32_bf16 v[64:67], v[168:171], v[156:159], v[64:67]
    ds_read_b128 v[116:119], v2 offset:4096
    v_mfma_f32_16x16x32_bf16 v[88:91], v[168:171], v[160:163], v[88:91]
    ds_read_b128 v[120:123], v2 offset:6144
    v_mfma_f32_16x16x32_bf16 v[20:23], v[172:175], v[148:151], v[20:23]
    ds_read_b64_tr_b16 v[128:129], v5 offset:0
    v_mfma_f32_16x16x32_bf16 v[44:47], v[172:175], v[152:155], v[44:47]
    ds_read_b64_tr_b16 v[130:131], v5 offset:512
    v_mfma_f32_16x16x32_bf16 v[68:71], v[172:175], v[156:159], v[68:71]
    ds_read_b64_tr_b16 v[132:133], v4 offset:8192
    v_mfma_f32_16x16x32_bf16 v[92:95], v[172:175], v[160:163], v[92:95]
    ds_read_b64_tr_b16 v[134:135], v4 offset:8704
    v_mfma_f32_16x16x32_bf16 v[24:27], v[176:179], v[148:151], v[24:27]
    ds_read_b64_tr_b16 v[136:137], v5 offset:8192
    v_mfma_f32_16x16x32_bf16 v[48:51], v[176:179], v[152:155], v[48:51]
    ds_read_b64_tr_b16 v[138:139], v5 offset:8704
    v_mfma_f32_16x16x32_bf16 v[72:75], v[176:179], v[156:159], v[72:75]
    ds_read_b64_tr_b16 v[140:141], v4 offset:16384
    v_mfma_f32_16x16x32_bf16 v[96:99], v[176:179], v[160:163], v[96:99]
    ds_read_b64_tr_b16 v[142:143], v4 offset:16896
    v_mfma_f32_16x16x32_bf16 v[28:31], v[148:151], v[180:183], v[28:31]
    ds_read_b64_tr_b16 v[144:145], v5 offset:16384
    v_mfma_f32_16x16x32_bf16 v[52:55], v[152:155], v[180:183], v[52:55]
    ds_read_b64_tr_b16 v[146:147], v5 offset:16896
    v_mfma_f32_16x16x32_bf16 v[76:79], v[156:159], v[180:183], v[76:79]
    v_mfma_f32_16x16x32_bf16 v[100:103], v[160:163], v[180:183], v[100:103]
    v_mfma_f32_16x16x32_bf16 v[32:35], v[148:151], v[184:187], v[32:35]
    v_mfma_f32_16x16x32_bf16 v[56:59], v[152:155], v[184:187], v[56:59]
    v_mfma_f32_16x16x32_bf16 v[80:83], v[156:159], v[184:187], v[80:83]
    v_mfma_f32_16x16x32_bf16 v[104:107], v[160:163], v[184:187], v[104:107]
    s_waitcnt lgkmcnt(13)
    v_mfma_f32_16x16x32_bf16 v[12:15], v[124:127], v[108:111], v[12:15]
    ds_read_b64_tr_b16 v[164:165], v4 offset:4096
    s_waitcnt lgkmcnt(13)
    v_mfma_f32_16x16x32_bf16 v[36:39], v[124:127], v[112:115], v[36:39]
    ds_read_b64_tr_b16 v[166:167], v4 offset:4608
    s_waitcnt lgkmcnt(13)
    v_mfma_f32_16x16x32_bf16 v[60:63], v[124:127], v[116:119], v[60:63]
    ds_read_b128 v[148:151], v3 offset:0
    s_waitcnt lgkmcnt(13)
    v_mfma_f32_16x16x32_bf16 v[84:87], v[124:127], v[120:123], v[84:87]
    ds_read_b128 v[152:155], v3 offset:2048
    s_waitcnt lgkmcnt(12)
    v_mfma_f32_16x16x32_bf16 v[16:19], v[128:131], v[108:111], v[16:19]
    ds_read_b128 v[156:159], v3 offset:4096
    v_mfma_f32_16x16x32_bf16 v[40:43], v[128:131], v[112:115], v[40:43]
    ds_read_b128 v[160:163], v3 offset:6144
    v_mfma_f32_16x16x32_bf16 v[64:67], v[128:131], v[116:119], v[64:67]
    ds_read_b64_tr_b16 v[168:169], v5 offset:4096
    v_mfma_f32_16x16x32_bf16 v[88:91], v[128:131], v[120:123], v[88:91]
    ds_read_b64_tr_b16 v[170:171], v5 offset:4608
    s_waitcnt lgkmcnt(14)
    v_mfma_f32_16x16x32_bf16 v[20:23], v[132:135], v[108:111], v[20:23]
    ds_read_b64_tr_b16 v[172:173], v4 offset:12288
    v_mfma_f32_16x16x32_bf16 v[44:47], v[132:135], v[112:115], v[44:47]
    ds_read_b64_tr_b16 v[174:175], v4 offset:12800
    v_mfma_f32_16x16x32_bf16 v[68:71], v[132:135], v[116:119], v[68:71]
    ds_read_b64_tr_b16 v[176:177], v5 offset:12288
    v_mfma_f32_16x16x32_bf16 v[92:95], v[132:135], v[120:123], v[92:95]
    ds_read_b64_tr_b16 v[178:179], v5 offset:12800
    s_waitcnt lgkmcnt(15)
    v_mfma_f32_16x16x32_bf16 v[24:27], v[136:139], v[108:111], v[24:27]
    ds_read_b64_tr_b16 v[180:181], v4 offset:20480
    v_mfma_f32_16x16x32_bf16 v[48:51], v[136:139], v[112:115], v[48:51]
    ds_read_b64_tr_b16 v[182:183], v4 offset:20992
    v_mfma_f32_16x16x32_bf16 v[72:75], v[136:139], v[116:119], v[72:75]
    ds_read_b64_tr_b16 v[184:185], v5 offset:20480
    v_mfma_f32_16x16x32_bf16 v[96:99], v[136:139], v[120:123], v[96:99]
    ds_read_b64_tr_b16 v[186:187], v5 offset:20992
    s_waitcnt lgkmcnt(15)
    v_mfma_f32_16x16x32_bf16 v[28:31], v[108:111], v[140:143], v[28:31]
    v_mfma_f32_16x16x32_bf16 v[52:55], v[112:115], v[140:143], v[52:55]
    v_mfma_f32_16x16x32_bf16 v[76:79], v[116:119], v[140:143], v[76:79]
    v_mfma_f32_16x16x32_bf16 v[100:103], v[120:123], v[140:143], v[100:103]
    v_mfma_f32_16x16x32_bf16 v[32:35], v[108:111], v[144:147], v[32:35]
    v_mfma_f32_16x16x32_bf16 v[56:59], v[112:115], v[144:147], v[56:59]
    v_mfma_f32_16x16x32_bf16 v[80:83], v[116:119], v[144:147], v[80:83]
    v_mfma_f32_16x16x32_bf16 v[104:107], v[120:123], v[144:147], v[104:107]
    s_waitcnt lgkmcnt(13)
    v_mfma_f32_16x16x32_bf16 v[12:15], v[164:167], v[148:151], v[12:15]
    s_add_u32 s33, s33, 40960
    s_cmp_ge_u32 s33, 163840
    s_cselect_b32 s33, 0, s33
    v_add_u32 v2, s33, v6
    v_add_u32 v3, s33, v7
    s_waitcnt lgkmcnt(12)
    v_mfma_f32_16x16x32_bf16 v[36:39], v[164:167], v[152:155], v[36:39]
    s_waitcnt lgkmcnt(11)
    v_mfma_f32_16x16x32_bf16 v[60:63], v[164:167], v[156:159], v[60:63]
    v_add_u32 v4, s33, v8
    v_add_u32 v5, s33, v9
    s_waitcnt lgkmcnt(0)
    s_barrier
    ds_read_b64_tr_b16 v[124:125], v4 offset:0
    v_mfma_f32_16x16x32_bf16 v[84:87], v[164:167], v[160:163], v[84:87]
    ds_read_b64_tr_b16 v[126:127], v4 offset:512
    v_mfma_f32_16x16x32_bf16 v[16:19], v[168:171], v[148:151], v[16:19]
    ds_read_b128 v[108:111], v2 offset:0
    v_mfma_f32_16x16x32_bf16 v[40:43], v[168:171], v[152:155], v[40:43]
    ds_read_b128 v[112:115], v2 offset:2048
    v_mfma_f32_16x16x32_bf16 v[64:67], v[168:171], v[156:159], v[64:67]
    ds_read_b128 v[116:119], v2 offset:4096
    v_mfma_f32_16x16x32_bf16 v[88:91], v[168:171], v[160:163], v[88:91]
    ds_read_b128 v[120:123], v2 offset:6144
    v_mfma_f32_16x16x32_bf16 v[20:23], v[172:175], v[148:151], v[20:23]
    ds_read_b64_tr_b16 v[128:129], v5 offset:0
    v_mfma_f32_16x16x32_bf16 v[44:47], v[172:175], v[152:155], v[44:47]
    ds_read_b64_tr_b16 v[130:131], v5 offset:512
    v_mfma_f32_16x16x32_bf16 v[68:71], v[172:175], v[156:159], v[68:71]
    ds_read_b64_tr_b16 v[132:133], v4 offset:8192
    v_mfma_f32_16x16x32_bf16 v[92:95], v[172:175], v[160:163], v[92:95]
    ds_read_b64_tr_b16 v[134:135], v4 offset:8704
    v_mfma_f32_16x16x32_bf16 v[24:27], v[176:179], v[148:151], v[24:27]
    ds_read_b64_tr_b16 v[136:137], v5 offset:8192
    v_mfma_f32_16x16x32_bf16 v[48:51], v[176:179], v[152:155], v[48:51]
    ds_read_b64_tr_b16 v[138:139], v5 offset:8704
    v_mfma_f32_16x16x32_bf16 v[72:75], v[176:179], v[156:159], v[72:75]
    ds_read_b64_tr_b16 v[140:141], v4 offset:16384
    v_mfma_f32_16x16x32_bf16 v[96:99], v[176:179], v[160:163], v[96:99]
    ds_read_b64_tr_b16 v[142:143], v4 offset:16896
    v_mfma_f32_16x16x32_bf16 v[28:31], v[148:151], v[180:183], v[28:31]
    ds_read_b64_tr_b16 v[144:145], v5 offset:16384
    v_mfma_f32_16x16x32_bf16 v[52:55], v[152:155], v[180:183], v[52:55]
    ds_read_b64_tr_b16 v[146:147], v5 offset:16896
    v_mfma_f32_16x16x32_bf16 v[76:79], v[156:159], v[180:183], v[76:79]
    v_mfma_f32_16x16x32_bf16 v[100:103], v[160:163], v[180:183], v[100:103]
    v_mfma_f32_16x16x32_bf16 v[32:35], v[148:151], v[184:187], v[32:35]
    v_mfma_f32_16x16x32_bf16 v[56:59], v[152:155], v[184:187], v[56:59]
    v_mfma_f32_16x16x32_bf16 v[80:83], v[156:159], v[184:187], v[80:83]
    s_sub_u32 s34, s34, 2
    s_cmp_lg_u32 s34, 0
    v_mfma_f32_16x16x32_bf16 v[104:107], v[160:163], v[184:187], v[104:107]
    s_cbranch_scc1 qkv_cloop
    s_waitcnt lgkmcnt(0)
    s_lshl_b32 s3, s40, 9
    v_lshl_add_u32 v2, v10, 4, s3
    v_lshl_add_u32 v3, v1, 2, s3
    s_lshl_b32 s3, s39, 8
    v_lshl_add_u32 v4, v1, 2, s3
    v_lshl_add_u32 v5, v10, 4, s3
    ds_read_b128 v[108:111], v2 offset:1024
    ds_read_b128 v[112:115], v2 offset:1088
    ds_read_b128 v[116:119], v2 offset:1152
    ds_read_b128 v[120:123], v2 offset:1280
    ds_read_b32 v124, v4 offset:0
    ds_read_b32 v126, v4 offset:512
    ds_read_b32 v128, v4 offset:64
    ds_read_b32 v130, v4 offset:576
    ds_read_b32 v132, v4 offset:128
    ds_read_b32 v134, v4 offset:640
    ds_read_b32 v136, v4 offset:192
    ds_read_b32 v138, v4 offset:704
    s_waitcnt lgkmcnt(0)
    ds_read_b32 v140, v3 offset:1344
    ds_read_b32 v142, v3 offset:1408
    ds_read_b128 v[144:147], v5 offset:0
    ds_read_b128 v[148:151], v5 offset:512
    ds_read_b128 v[152:155], v5 offset:64
    ds_read_b128 v[156:159], v5 offset:576
    ds_read_b128 v[160:163], v5 offset:128
    ds_read_b128 v[164:167], v5 offset:640
    ds_read_b128 v[168:171], v5 offset:192
    ds_read_b128 v[172:175], v5 offset:704
    s_add_u32 s16, s4, 0x400000
    s_addc_u32 s17, s5, 0
    s_mov_b32 s18, 0x400000
    s_mov_b32 s19, 0x20000
    s_add_u32 s20, s4, 0x800000
    s_addc_u32 s21, s5, 0
    s_mov_b32 s22, 0x800000
    s_mov_b32 s23, 0x20000
    s_lshl_b32 s37, s31, 2
    s_lshl_b32 s3, s39, 1
    s_add_u32 s37, s37, s3
    s_add_u32 s3, s32, 0
    s_and_b32 s3, s3, 15
    s_lshl_b32 s3, s3, 1
    s_add_u32 s3, s3, s40
    s_lshl_b32 s3, s3, 6
    s_add_u32 s3, s3, s37
    s_lshl_b32 s41, s3, 11
    s_add_u32 s42, s41, 2048
    s_add_u32 s3, s32, 0
    s_and_b32 s3, s3, 15
    s_lshl_b32 s3, s3, 1
    s_add_u32 s3, s3, s40
    s_lshl_b32 s3, s3, 6
    s_add_u32 s3, s3, s37
    s_lshl_b32 s43, s3, 12
    s_add_u32 s44, s43, 4096
    s_add_u32 s3, s32, 0
    s_and_b32 s3, s3, 15
    s_lshl_b32 s3, s3, 1
    s_add_u32 s3, s3, s40
    s_lshl_b32 s3, s3, 6
    s_add_u32 s3, s3, s37
    s_lshl_b32 s45, s3, 12
    s_add_u32 s46, s45, 4096
    v_lshlrev_b32 v2, 9, v10
    v_lshl_add_u32 v2, v1, 4, v2
    s_waitcnt lgkmcnt(0)
    v_pk_fma_f32 v[12:13], v[108:109], v[124:125], v[12:13] op_sel_hi:[1,0,1]
    v_pk_fma_f32 v[14:15], v[110:111], v[124:125], v[14:15] op_sel_hi:[1,0,1]
    v_pk_fma_f32 v[16:17], v[112:113], v[124:125], v[16:17] op_sel_hi:[1,0,1]
    v_pk_fma_f32 v[18:19], v[114:115], v[124:125], v[18:19] op_sel_hi:[1,0,1]
    v_pk_fma_f32 v[20:21], v[116:117], v[124:125], v[20:21] op_sel_hi:[1,0,1]
    v_pk_fma_f32 v[22:23], v[118:119], v[124:125], v[22:23] op_sel_hi:[1,0,1]
    v_pk_fma_f32 v[24:25], v[120:121], v[124:125], v[24:25] op_sel_hi:[1,0,1]
    v_pk_fma_f32 v[26:27], v[122:123], v[124:125], v[26:27] op_sel_hi:[1,0,1]
    v_pk_fma_f32 v[28:29], v[144:145], v[140:141], v[28:29] op_sel_hi:[1,0,1]
    v_pk_fma_f32 v[30:31], v[146:147], v[140:141], v[30:31] op_sel_hi:[1,0,1]
    v_pk_fma_f32 v[32:33], v[144:145], v[142:143], v[32:33] op_sel_hi:[1,0,1]
    v_pk_fma_f32 v[34:35], v[146:147], v[142:143], v[34:35] op_sel_hi:[1,0,1]
    v_pk_mul_f32 v[20:21], v[20:21], v[126:127] op_sel_hi:[1,0]
    v_pk_mul_f32 v[22:23], v[22:23], v[126:127] op_sel_hi:[1,0]
    v_pk_mul_f32 v[24:25], v[24:25], v[126:127] op_sel_hi:[1,0]
    v_pk_mul_f32 v[26:27], v[26:27], v[126:127] op_sel_hi:[1,0]
    v_mul_f32 v126, 0x3e8293ee, v126
    v_pk_mul_f32 v[28:29], v[28:29], v[148:149]
    v_pk_mul_f32 v[30:31], v[30:31], v[150:151]
    v_pk_mul_f32 v[32:33], v[32:33], v[148:149]
    v_pk_mul_f32 v[34:35], v[34:35], v[150:151]
    v_pk_mul_f32 v[12:13], v[12:13], v[126:127] op_sel_hi:[1,0]
    v_pk_mul_f32 v[14:15], v[14:15], v[126:127] op_sel_hi:[1,0]
    v_pk_mul_f32 v[16:17], v[16:17], v[126:127] op_sel_hi:[1,0]
    v_pk_mul_f32 v[18:19], v[18:19], v[126:127] op_sel_hi:[1,0]
    v_cvt_pk_bf16_f32 v176, v20, v21
    v_cvt_pk_bf16_f32 v177, v22, v23
    v_cvt_pk_bf16_f32 v178, v24, v25
    v_cvt_pk_bf16_f32 v179, v26, v27
    buffer_store_dwordx4 v[176:179], v2, s[20:23], s43 offen offset:0 sc1
    v_cvt_pk_bf16_f32 v180, v12, v13
    v_cvt_pk_bf16_f32 v181, v14, v15
    v_cvt_pk_bf16_f32 v182, v16, v17
    v_cvt_pk_bf16_f32 v183, v18, v19
    buffer_store_dwordx4 v[180:183], v2, s[16:19], s41 offen offset:0 sc1
    v_pk_fma_f32 v[36:37], v[108:109], v[128:129], v[36:37] op_sel_hi:[1,0,1]
    v_pk_fma_f32 v[38:39], v[110:111], v[128:129], v[38:39] op_sel_hi:[1,0,1]
    v_pk_fma_f32 v[40:41], v[112:113], v[128:129], v[40:41] op_sel_hi:[1,0,1]
    v_pk_fma_f32 v[42:43], v[114:115], v[128:129], v[42:43] op_sel_hi:[1,0,1]
    v_pk_fma_f32 v[44:45], v[116:117], v[128:129], v[44:45] op_sel_hi:[1,0,1]
    v_pk_fma_f32 v[46:47], v[118:119], v[128:129], v[46:47] op_sel_hi:[1,0,1]
    v_pk_fma_f32 v[48:49], v[120:121], v[128:129], v[48:49] op_sel_hi:[1,0,1]
    v_pk_fma_f32 v[50:51], v[122:123], v[128:129], v[50:51] op_sel_hi:[1,0,1]
    v_pk_fma_f32 v[52:53], v[152:153], v[140:141], v[52:53] op_sel_hi:[1,0,1]
    v_pk_fma_f32 v[54:55], v[154:155], v[140:141], v[54:55] op_sel_hi:[1,0,1]
    v_pk_fma_f32 v[56:57], v[152:153], v[142:143], v[56:57] op_sel_hi:[1,0,1]
    v_pk_fma_f32 v[58:59], v[154:155], v[142:143], v[58:59] op_sel_hi:[1,0,1]
    v_pk_mul_f32 v[44:45], v[44:45], v[130:131] op_sel_hi:[1,0]
    v_pk_mul_f32 v[46:47], v[46:47], v[130:131] op_sel_hi:[1,0]
    v_pk_mul_f32 v[48:49], v[48:49], v[130:131] op_sel_hi:[1,0]
    v_pk_mul_f32 v[50:51], v[50:51], v[130:131] op_sel_hi:[1,0]
    v_mul_f32 v130, 0x3e8293ee, v130
    v_pk_mul_f32 v[52:53], v[52:53], v[156:157]
    v_pk_mul_f32 v[54:55], v[54:55], v[158:159]
    v_pk_mul_f32 v[56:57], v[56:57], v[156:157]
    v_pk_mul_f32 v[58:59], v[58:59], v[158:159]
    v_pk_mul_f32 v[36:37], v[36:37], v[130:131] op_sel_hi:[1,0]
    v_pk_mul_f32 v[38:39], v[38:39], v[130:131] op_sel_hi:[1,0]
    v_pk_mul_f32 v[40:41], v[40:41], v[130:131] op_sel_hi:[1,0]
    v_pk_mul_f32 v[42:43], v[42:43], v[130:131] op_sel_hi:[1,0]
    v_cvt_pk_bf16_f32 v184, v44, v45
    v_cvt_pk_bf16_f32 v185, v46, v47
    v_cvt_pk_bf16_f32 v186, v48, v49
    v_cvt_pk_bf16_f32 v187, v50, v51
    buffer_store_dwordx4 v[184:187], v2, s[20:23], s43 offen offset:256 sc1
    v_cvt_pk_bf16_f32 v188, v28, v29
    v_cvt_pk_bf16_f32 v189, v30, v31
    v_cvt_pk_bf16_f32 v190, v52, v53
    v_cvt_pk_bf16_f32 v191, v54, v55
    buffer_store_dwordx4 v[188:191], v2, s[20:23], s45 offen offset:2048 sc1
    v_cvt_pk_bf16_f32 v192, v32, v33
    v_cvt_pk_bf16_f32 v193, v34, v35
    v_cvt_pk_bf16_f32 v194, v56, v57
    v_cvt_pk_bf16_f32 v195, v58, v59
    buffer_store_dwordx4 v[192:195], v2, s[20:23], s45 offen offset:2304 sc1
    v_cvt_pk_bf16_f32 v196, v36, v37
    v_cvt_pk_bf16_f32 v197, v38, v39
    v_cvt_pk_bf16_f32 v198, v40, v41
    v_cvt_pk_bf16_f32 v199, v42, v43
    buffer_store_dwordx4 v[196:199], v2, s[16:19], s41 offen offset:256 sc1
    v_pk_fma_f32 v[60:61], v[108:109], v[132:133], v[60:61] op_sel_hi:[1,0,1]
    v_pk_fma_f32 v[62:63], v[110:111], v[132:133], v[62:63] op_sel_hi:[1,0,1]
    v_pk_fma_f32 v[64:65], v[112:113], v[132:133], v[64:65] op_sel_hi:[1,0,1]
    v_pk_fma_f32 v[66:67], v[114:115], v[132:133], v[66:67] op_sel_hi:[1,0,1]
    v_pk_fma_f32 v[68:69], v[116:117], v[132:133], v[68:69] op_sel_hi:[1,0,1]
    v_pk_fma_f32 v[70:71], v[118:119], v[132:133], v[70:71] op_sel_hi:[1,0,1]
    v_pk_fma_f32 v[72:73], v[120:121], v[132:133], v[72:73] op_sel_hi:[1,0,1]
    v_pk_fma_f32 v[74:75], v[122:123], v[132:133], v[74:75] op_sel_hi:[1,0,1]
    v_pk_fma_f32 v[76:77], v[160:161], v[140:141], v[76:77] op_sel_hi:[1,0,1]
    v_pk_fma_f32 v[78:79], v[162:163], v[140:141], v[78:79] op_sel_hi:[1,0,1]
    v_pk_fma_f32 v[80:81], v[160:161], v[142:143], v[80:81] op_sel_hi:[1,0,1]
    v_pk_fma_f32 v[82:83], v[162:163], v[142:143], v[82:83] op_sel_hi:[1,0,1]
    v_pk_mul_f32 v[68:69], v[68:69], v[134:135] op_sel_hi:[1,0]
    v_pk_mul_f32 v[70:71], v[70:71], v[134:135] op_sel_hi:[1,0]
    v_pk_mul_f32 v[72:73], v[72:73], v[134:135] op_sel_hi:[1,0]
    v_pk_mul_f32 v[74:75], v[74:75], v[134:135] op_sel_hi:[1,0]
    v_mul_f32 v134, 0x3e8293ee, v134
    v_pk_mul_f32 v[76:77], v[76:77], v[164:165]
    v_pk_mul_f32 v[78:79], v[78:79], v[166:167]
    v_pk_mul_f32 v[80:81], v[80:81], v[164:165]
    v_pk_mul_f32 v[82:83], v[82:83], v[166:167]
    v_pk_mul_f32 v[60:61], v[60:61], v[134:135] op_sel_hi:[1,0]
    v_pk_mul_f32 v[62:63], v[62:63], v[134:135] op_sel_hi:[1,0]
    v_pk_mul_f32 v[64:65], v[64:65], v[134:135] op_sel_hi:[1,0]
    v_pk_mul_f32 v[66:67], v[66:67], v[134:135] op_sel_hi:[1,0]
    v_cvt_pk_bf16_f32 v200, v68, v69
    v_cvt_pk_bf16_f32 v201, v70, v71
    v_cvt_pk_bf16_f32 v202, v72, v73
    v_cvt_pk_bf16_f32 v203, v74, v75
    buffer_store_dwordx4 v[200:203], v2, s[20:23], s44 offen offset:0 sc1
    v_cvt_pk_bf16_f32 v204, v60, v61
    v_cvt_pk_bf16_f32 v205, v62, v63
    v_cvt_pk_bf16_f32 v206, v64, v65
    v_cvt_pk_bf16_f32 v207, v66, v67
    buffer_store_dwordx4 v[204:207], v2, s[16:19], s42 offen offset:0 sc1
    v_pk_fma_f32 v[84:85], v[108:109], v[136:137], v[84:85] op_sel_hi:[1,0,1]
    v_pk_fma_f32 v[86:87], v[110:111], v[136:137], v[86:87] op_sel_hi:[1,0,1]
    v_pk_fma_f32 v[88:89], v[112:113], v[136:137], v[88:89] op_sel_hi:[1,0,1]
    v_pk_fma_f32 v[90:91], v[114:115], v[136:137], v[90:91] op_sel_hi:[1,0,1]
    v_pk_fma_f32 v[92:93], v[116:117], v[136:137], v[92:93] op_sel_hi:[1,0,1]
    v_pk_fma_f32 v[94:95], v[118:119], v[136:137], v[94:95] op_sel_hi:[1,0,1]
    v_pk_fma_f32 v[96:97], v[120:121], v[136:137], v[96:97] op_sel_hi:[1,0,1]
    v_pk_fma_f32 v[98:99], v[122:123], v[136:137], v[98:99] op_sel_hi:[1,0,1]
    v_pk_fma_f32 v[100:101], v[168:169], v[140:141], v[100:101] op_sel_hi:[1,0,1]
    v_pk_fma_f32 v[102:103], v[170:171], v[140:141], v[102:103] op_sel_hi:[1,0,1]
    v_pk_fma_f32 v[104:105], v[168:169], v[142:143], v[104:105] op_sel_hi:[1,0,1]
    v_pk_fma_f32 v[106:107], v[170:171], v[142:143], v[106:107] op_sel_hi:[1,0,1]
    v_pk_mul_f32 v[92:93], v[92:93], v[138:139] op_sel_hi:[1,0]
    v_pk_mul_f32 v[94:95], v[94:95], v[138:139] op_sel_hi:[1,0]
    v_pk_mul_f32 v[96:97], v[96:97], v[138:139] op_sel_hi:[1,0]
    v_pk_mul_f32 v[98:99], v[98:99], v[138:139] op_sel_hi:[1,0]
    v_mul_f32 v138, 0x3e8293ee, v138
    v_pk_mul_f32 v[100:101], v[100:101], v[172:173]
    v_pk_mul_f32 v[102:103], v[102:103], v[174:175]
    v_pk_mul_f32 v[104:105], v[104:105], v[172:173]
    v_pk_mul_f32 v[106:107], v[106:107], v[174:175]
    v_pk_mul_f32 v[84:85], v[84:85], v[138:139] op_sel_hi:[1,0]
    v_pk_mul_f32 v[86:87], v[86:87], v[138:139] op_sel_hi:[1,0]
    v_pk_mul_f32 v[88:89], v[88:89], v[138:139] op_sel_hi:[1,0]
    v_pk_mul_f32 v[90:91], v[90:91], v[138:139] op_sel_hi:[1,0]
    v_cvt_pk_bf16_f32 v208, v92, v93
    v_cvt_pk_bf16_f32 v209, v94, v95
    v_cvt_pk_bf16_f32 v210, v96, v97
    v_cvt_pk_bf16_f32 v211, v98, v99
    buffer_store_dwordx4 v[208:211], v2, s[20:23], s44 offen offset:256 sc1
    v_cvt_pk_bf16_f32 v212, v76, v77
    v_cvt_pk_bf16_f32 v213, v78, v79
    v_cvt_pk_bf16_f32 v214, v100, v101
    v_cvt_pk_bf16_f32 v215, v102, v103
    buffer_store_dwordx4 v[212:215], v2, s[20:23], s46 offen offset:2048 sc1
    v_cvt_pk_bf16_f32 v216, v80, v81
    v_cvt_pk_bf16_f32 v217, v82, v83
    v_cvt_pk_bf16_f32 v218, v104, v105
    v_cvt_pk_bf16_f32 v219, v106, v107
    buffer_store_dwordx4 v[216:219], v2, s[20:23], s46 offen offset:2304 sc1
    v_cvt_pk_bf16_f32 v220, v84, v85
    v_cvt_pk_bf16_f32 v221, v86, v87
    v_cvt_pk_bf16_f32 v222, v88, v89
    v_cvt_pk_bf16_f32 v223, v90, v91
    buffer_store_dwordx4 v[220:223], v2, s[16:19], s42 offen offset:256 sc1
    s_lshl_b32 s43, s32, 1
    s_add_u32 s43, s43, s40
    s_lshl_b32 s43, s43, 5
    s_lshl_b32 s3, s31, 1
    s_add_u32 s43, s43, s3
    s_add_u32 s43, s43, s39
    s_lshl_b32 s92, s43, 7
qkv_end:
    s_mov_b32 s30, s29
    s_load_dwordx2 s[6:7], s[0:1], 72
    s_load_dwordx2 s[48:49], s[0:1], 32
    s_load_dwordx2 s[50:51], s[0:1], 48
    s_and_b32 s3, s2, 7
    s_lshr_b32 s37, s2, 3
    s_lshl_b32 s31, s3, 2
    s_lshr_b32 s3, s37, 3
    s_add_u32 s31, s31, s3
    s_and_b32 s35, s30, 3
    s_lshr_b32 s33, s30, 2
    s_and_b32 s32, s37, 7
    s_lshl_b32 s32, s32, 2
    s_add_u32 s32, s32, s35
    s_lshl_b32 s32, s32, 1
    v_lshlrev_b32 v4, 4, v0
    v_and_b32 v201, 0x23, v0
    v_bfe_u32 v5, v0, 2, 1
    v_lshl_or_b32 v201, v5, 4, v201
    v_bfe_u32 v5, v0, 3, 2
    v_lshl_or_b32 v201, v5, 2, v201
    v_lshlrev_b32 v201, 4, v201
    s_mov_b32 s36, 1
    s_waitcnt lgkmcnt(0)
    s_add_u32 s8, s4, 0x400000
    s_addc_u32 s9, s5, 0
    s_mov_b32 s10, 0x400000
    s_mov_b32 s11, 0x20000
    s_add_u32 s12, s4, 0x800000
    s_addc_u32 s13, s5, 0
    s_mov_b32 s14, 0x800000
    s_mov_b32 s15, 0x20000
    s_add_u32 s16, s4, 0x1000000
    s_addc_u32 s17, s5, 0
    s_mov_b32 s18, 0x400000
    s_mov_b32 s19, 0x20000
attn_retry:
    s_cmp_lt_u32 s2, 112
    s_cbranch_scc0 attn_sj2
    s_mov_b32 s20, s48
    s_mov_b32 s21, s49
    s_mov_b32 s22, 0x700000
    s_mov_b32 s23, 0x20000
    s_add_u32 s24, s4, 0x3400000
    s_addc_u32 s25, s5, 0
    s_mov_b32 s26, 0x700000
    s_mov_b32 s27, 0x20000
    s_mul_i32 s37, s2, 2341
    s_lshr_b32 s37, s37, 16
    s_mul_i32 s43, s37, 28
    s_sub_u32 s43, s2, s43
    s_lshl_b32 s43, s43, 2
    s_add_u32 s43, s43, s35
    s_mul_i32 s70, s37, 1835008
    s_lshl_b32 s44, s43, 6
    s_add_u32 s70, s70, s44
    s_mov_b32 s71, 229376
    s_mov_b32 s76, 7168
    s_mul_i32 s78, s37, 14336
    s_lshl_b32 s44, s43, 7
    s_add_u32 s78, s78, s44
    s_mul_i32 s44, s43, 9363
    s_lshr_b32 s44, s44, 16
    s_mul_i32 s45, s44, 7
    s_sub_u32 s45, s43, s45
    s_mul_i32 s72, s44, 458752
    s_mul_i32 s44, s37, 114688
    s_add_u32 s72, s72, s44
    s_lshl_b32 s44, s45, 1
    s_cmp_gt_u32 s45, 3
    s_cselect_b32 s46, 1, 0
    s_sub_u32 s44, s44, s46
    s_lshl_b32 s44, s44, 11
    s_add_u32 s72, s72, s44
    s_cmp_eq_u32 s45, 3
    s_cselect_b32 s75, 7, 1
    s_cselect_b32 s47, 1, 0
    s_lshl_b32 s75, s75, 11
    s_mov_b32 s73, 1024
    s_mov_b32 s74, 27648
    s_mov_b32 s44, 0
    s_branch attn_sjd
attn_sj2:
    s_mov_b32 s20, s50
    s_mov_b32 s21, s51
    s_mov_b32 s22, 0x700000
    s_mov_b32 s23, 0x20000
    s_add_u32 s24, s4, 0x3c00000
    s_addc_u32 s25, s5, 0
    s_mov_b32 s26, 0x700000
    s_mov_b32 s27, 0x20000
    s_sub_u32 s37, s2, 112
    s_mov_b32 s45, 458752
    s_mov_b32 s44, 0
    s_lshl_b32 s70, s37, 16
    s_lshl_b32 s43, s35, 9
    s_add_u32 s70, s70, s43
    s_mov_b32 s71, 64
    s_mov_b32 s76, 2048
    s_lshl_b32 s43, s35, 2
    s_mul_i32 s72, s43, s45
    s_lshr_b32 s43, s37, 1
    s_lshl_b32 s43, s43, 13
    s_add_u32 s72, s72, s43
    s_and_b32 s43, s37, 1
    s_lshl_b32 s43, s43, 10
    s_add_u32 s72, s72, s43
    s_mov_b32 s75, 2048
    s_mov_b32 s73, 4096
    s_sub_u32 s74, s45, 4096
    s_mov_b32 s78, 0
    s_mov_b32 s47, 0
attn_sjd:
    v_lshrrev_b32 v198, 2, v0
    v_mul_lo_u32 v198, s76, v198
    v_and_b32 v7, 3, v0
    v_lshl_add_u32 v198, v7, 4, v198
    v_lshlrev_b32 v199, 4, v7
    v_bfe_u32 v7, v0, 2, 2
    v_lshl_add_u32 v199, v7, 6, v199
    s_lshl_b32 s77, s35, 14
    s_add_u32 s77, s77, 98304
    s_lshr_b32 s45, 512, s44
    s_lshl_b32 s46, 256, s44
    v_lshrrev_b32 v7, 5, v0
    v_lshl_add_u32 v199, v7, 10, v199
    v_bfe_u32 v7, v0, 4, 1
    v_mul_lo_u32 v7, s45, v7
    v_add3_u32 v199, v199, v7, s77
    v_and_b32 v7, 3, v0
    v_lshlrev_b32 v7, 3, v7
    v_mul_lo_u32 v7, s47, v7
    v_sub_u32 v199, v199, v7
    v_add_u32 v200, s46, v199
    s_lshl_b32 s85, s47, 1
    s_lshl_b32 s85, 8, s85
    v_add_u32 v202, s85, v199
    v_add_u32 v203, s85, v200
    s_lshl_b32 s76, s76, 4
    s_add_u32 s80, s4, 0x2700000
    s_addc_u32 s81, s5, 0
    s_mov_b32 s82, 0xe000
    s_mov_b32 s83, 0x20000
    v_mov_b32 v212, 0
    v_mov_b32 v213, 0
    v_mov_b32 v214, 0
    v_mov_b32 v215, 0
    v_mov_b32 v216, 0
    v_mov_b32 v217, 0
    v_mov_b32 v218, 0
    v_mov_b32 v219, 0
    v_mov_b32 v220, 0x3f803f80
    v_mov_b32 v221, 0x3f803f80
    v_mov_b32 v222, 0x3f803f80
    v_mov_b32 v223, 0x3f803f80
    v_mov_b32 v196, 0xdddddddd
    v_bfe_u32 v5, v0, 2, 1
    v_cmp_eq_u32 vcc, 0, v5
    v_mov_b32 v6, 0x3f803f80
    s_nop 0
    v_cndmask_b32 v192, 0, v6, vcc
    v_cndmask_b32 v193, 0, v6, vcc
    v_sub_u32 v194, v6, v192
    v_sub_u32 v195, v6, v192
    s_lshl_b32 s37, s33, 14
    v_add_u32 v5, s37, v201
    v_mov_b32 v2, v5
    v_add_u32 v3, 32768, v5
    s_mov_b32 s41, 0
    v_mov_b32 v6, 0xff800000
    v_mov_b32 v7, 0xff800000
    v_mov_b32 v120, 0
    v_mov_b32 v121, 0
    v_mov_b32 v122, 0
    v_mov_b32 v123, 0
    v_mov_b32 v124, 0
    v_mov_b32 v125, 0
    v_mov_b32 v126, 0
    v_mov_b32 v127, 0
    v_mov_b32 v128, 0
    v_mov_b32 v129, 0
    v_mov_b32 v130, 0
    v_mov_b32 v131, 0
    v_mov_b32 v132, 0
    v_mov_b32 v133, 0
    v_mov_b32 v134, 0
    v_mov_b32 v135, 0
    v_mov_b32 v136, 0
    v_mov_b32 v137, 0
    v_mov_b32 v138, 0
    v_mov_b32 v139, 0
    v_mov_b32 v140, 0
    v_mov_b32 v141, 0
    v_mov_b32 v142, 0
    v_mov_b32 v143, 0
    v_mov_b32 v144, 0
    v_mov_b32 v145, 0
    v_mov_b32 v146, 0
    v_mov_b32 v147, 0
    v_mov_b32 v148, 0
    v_mov_b32 v149, 0
    v_mov_b32 v150, 0
    v_mov_b32 v151, 0
    v_mov_b32 v152, 0
    v_mov_b32 v153, 0
    v_mov_b32 v154, 0
    v_mov_b32 v155, 0
    v_mov_b32 v156, 0
    v_mov_b32 v157, 0
    v_mov_b32 v158, 0
    v_mov_b32 v159, 0
    v_mov_b32 v104, 0
    v_mov_b32 v105, 0
    v_mov_b32 v106, 0
    v_mov_b32 v107, 0
    v_mov_b32 v108, 0
    v_mov_b32 v109, 0
    v_mov_b32 v110, 0
    v_mov_b32 v111, 0
    v_mov_b32 v112, 0
    v_mov_b32 v113, 0
    v_mov_b32 v114, 0
    v_mov_b32 v115, 0
    v_mov_b32 v116, 0
    v_mov_b32 v117, 0
    v_mov_b32 v118, 0
    v_mov_b32 v119, 0
    v_mov_b32 v176, 0
    v_mov_b32 v177, 0
    v_mov_b32 v178, 0
    v_mov_b32 v179, 0
    v_mov_b32 v180, 0
    v_mov_b32 v181, 0
    v_mov_b32 v182, 0
    v_mov_b32 v183, 0
    v_mov_b32 v184, 0
    v_mov_b32 v185, 0
    v_mov_b32 v186, 0
    v_mov_b32 v187, 0
    v_mov_b32 v188, 0
    v_mov_b32 v189, 0
    v_mov_b32 v190, 0
    v_mov_b32 v191, 0
    s_cmp_lg_u32 s36, 1
    s_cbranch_scc1 attn_go
    s_add_u32 s88, s4, 0x4400000
    s_addc_u32 s89, s5, 0
    s_mov_b32 s90, 0xe1400
    s_mov_b32 s91, 0x20000
    s_cmp_lt_u32 s30, 4
    s_cbranch_scc0 attn_ns
    v_lshlrev_b32 v240, 7, v0
    v_mov_b32 v241, 1
    s_waitcnt vmcnt(0)
    s_mov_b64 exec, 1
    buffer_store_dword v241, v240, s[88:91], s92 offen sc1
    s_mov_b64 exec, -1
attn_ns:
    s_cmp_lg_u32 s30, 4
    s_cbranch_scc1 attn_pdx
    s_lshl_b32 s43, s31, 12
    v_min_u32 v244, 31, v0
    v_lshlrev_b32 v244, 7, v244
    s_mov_b32 s87, 0x40000
    s_mov_b32 s86, 0x1
attn_plx:
    buffer_load_dword v240, v244, s[88:91], s43 offen sc1
    s_waitcnt vmcnt(0)
    v_cmp_ne_u32 vcc, s86, v240
    s_sub_u32 s87, s87, 1
    s_nop 3
    s_cbranch_vccz attn_pdx
    s_sleep 6
    s_cmp_lg_u32 s87, 0
    s_cbranch_scc1 attn_plx
attn_pdx:
    s_barrier
attn_go:
    s_lshl_b32 s37, s31, 6
    s_add_u32 s37, s37, s32
    s_lshl_b32 s37, s37, 11
    buffer_load_dwordx4 v[8:11], v4, s[8:11], s37 offen offset:0 sc1
    buffer_load_dwordx4 v[12:15], v4, s[8:11], s37 offen offset:1024 sc1
    buffer_load_dwordx4 v[16:19], v4, s[8:11], s37 offen offset:2048 sc1
    buffer_load_dwordx4 v[20:23], v4, s[8:11], s37 offen offset:3072 sc1
    s_lshl_b32 s38, s31, 18
    buffer_load_dwordx4 v[160:163], v4, s[12:15], s38 offen offset:0 sc1
    buffer_load_dwordx4 v[164:167], v4, s[12:15], s38 offen offset:1024 sc1
    s_lshl_b32 s39, s33, 5
    s_add_u32 s39, s39, s35
    s_lshl_b32 s39, s39, 12
    s_add_u32 s39, s39, s38
    s_lshl_b32 s40, s30, 12
    s_mov_b32 m0, s40
    s_nop 0
    buffer_load_dwordx4 v4, s[12:15], s39 offen offset:0 sc1 lds
    buffer_load_dwordx4 v4, s[12:15], s39 offen offset:1024 sc1 lds
    buffer_load_dwordx4 v4, s[12:15], s39 offen offset:2048 sc1 lds
    buffer_load_dwordx4 v4, s[12:15], s39 offen offset:3072 sc1 lds
    s_add_u32 s39, s39, 16384
    s_mov_b32 s34, s36
    s_waitcnt vmcnt(4)
attn_mx:
    v_mfma_f32_32x32x16_bf16 v[56:71], v[160:163], v[8:11], 0
    v_mfma_f32_32x32x16_bf16 v[56:71], v[164:167], v[12:15], v[56:71]
    v_mfma_f32_32x32x16_bf16 v[72:87], v[160:163], v[16:19], 0
    v_mfma_f32_32x32x16_bf16 v[72:87], v[164:167], v[20:23], v[72:87]
    s_nop 15
    v_max3_f32 v6, v56, v57, v6
    v_max3_f32 v6, v58, v59, v6
    v_max3_f32 v6, v60, v61, v6
    v_max3_f32 v6, v62, v63, v6
    v_max3_f32 v6, v64, v65, v6
    v_max3_f32 v6, v66, v67, v6
    v_max3_f32 v6, v68, v69, v6
    v_max3_f32 v6, v70, v71, v6
    v_max3_f32 v7, v72, v73, v7
    v_max3_f32 v7, v74, v75, v7
    v_max3_f32 v7, v76, v77, v7
    v_max3_f32 v7, v78, v79, v7
    v_max3_f32 v7, v80, v81, v7
    v_max3_f32 v7, v82, v83, v7
    v_max3_f32 v7, v84, v85, v7
    v_max3_f32 v7, v86, v87, v7
    s_sub_u32 s34, s34, 1
    s_cmp_eq_u32 s34, 0
    s_cbranch_scc1 attn_mxd
    s_add_u32 s38, s38, 4096
    buffer_load_dwordx4 v[160:163], v4, s[12:15], s38 offen offset:0 sc1
    buffer_load_dwordx4 v[164:167], v4, s[12:15], s38 offen offset:1024 sc1
    s_waitcnt vmcnt(0)
    s_branch attn_mx
attn_mxd:
    v_mov_b32 v24, v6
    v_mov_b32 v40, v7
    s_nop 1
    v_permlane32_swap_b32 v6, v24
    v_permlane32_swap_b32 v7, v40
    s_nop 1
    v_max_f32 v6, v6, v24
    v_max_f32 v7, v7, v40
    v_sub_f32 v24, 0, v6
    v_sub_f32 v25, 0, v6
    v_sub_f32 v26, 0, v6
    v_sub_f32 v27, 0, v6
    v_sub_f32 v28, 0, v6
    v_sub_f32 v29, 0, v6
    v_sub_f32 v30, 0, v6
    v_sub_f32 v31, 0, v6
    v_sub_f32 v32, 0, v6
    v_sub_f32 v33, 0, v6
    v_sub_f32 v34, 0, v6
    v_sub_f32 v35, 0, v6
    v_sub_f32 v36, 0, v6
    v_sub_f32 v37, 0, v6
    v_sub_f32 v38, 0, v6
    v_sub_f32 v39, 0, v6
    v_sub_f32 v40, 0, v7
    v_sub_f32 v41, 0, v7
    v_sub_f32 v42, 0, v7
    v_sub_f32 v43, 0, v7
    v_sub_f32 v44, 0, v7
    v_sub_f32 v45, 0, v7
    v_sub_f32 v46, 0, v7
    v_sub_f32 v47, 0, v7
    v_sub_f32 v48, 0, v7
    v_sub_f32 v49, 0, v7
    v_sub_f32 v50, 0, v7
    v_sub_f32 v51, 0, v7
    v_sub_f32 v52, 0, v7
    v_sub_f32 v53, 0, v7
    v_sub_f32 v54, 0, v7
    v_sub_f32 v55, 0, v7
    s_waitcnt vmcnt(0)
    s_barrier
    ds_read_b128 v[160:163], v2 offset:0
    ds_read_b128 v[164:167], v2 offset:1024
    ds_read_b128 v[168:171], v2 offset:4096
    ds_read_b128 v[172:175], v2 offset:5120
    s_waitcnt lgkmcnt(2)
    v_mfma_f32_32x32x16_bf16 v[56:71], v[160:163], v[8:11], v[24:39]
    v_mfma_f32_32x32x16_bf16 v[56:71], v[164:167], v[12:15], v[56:71]
    v_mfma_f32_32x32x16_bf16 v[72:87], v[160:163], v[16:19], v[40:55]
    v_mfma_f32_32x32x16_bf16 v[72:87], v[164:167], v[20:23], v[72:87]
    s_add_u32 m0, s40, 32768
    s_nop 0
    buffer_load_dwordx4 v4, s[12:15], s39 offen offset:0 sc1 lds
    buffer_load_dwordx4 v4, s[12:15], s39 offen offset:1024 sc1 lds
    buffer_load_dwordx4 v4, s[12:15], s39 offen offset:2048 sc1 lds
    buffer_load_dwordx4 v4, s[12:15], s39 offen offset:3072 sc1 lds
    s_add_u32 s39, s39, 16384
    s_mov_b32 s34, 0
    s_nop 7
    s_nop 1
    s_cmp_eq_u32 s33, 0
    s_cbranch_scc1 attn_mt
    s_add_u32 s37, s36, s30
    s_cmp_lg_u32 s37, 5
    s_cbranch_scc1 attn_mt
    s_mov_b32 s56, s6
    s_mov_b32 s57, s7
    s_mov_b32 s58, 0x100
    s_mov_b32 s59, 0x20000
    s_and_b32 s37, s2, 3
    s_lshl_b32 s37, s37, 6
    v_mov_b32 v240, 4
    v_mov_b32 v241, 1
    s_mov_b64 exec, 1
    buffer_atomic_add v241, v240, s[56:59], s37 offen sc1
    s_mov_b64 exec, -1
attn_mt:
    s_cmp_eq_u32 s33, 0
    s_cbranch_scc1 attn_loop1
    s_cmp_lt_u32 s2, 224
    s_cselect_b32 s26, s26, 0
.p2align 3
attn_loop2:
    s_waitcnt lgkmcnt(0)
    v_mfma_f32_32x32x16_bf16 v[88:103], v[168:171], v[8:11], v[24:39]
    v_exp_f32 v56, v56
    v_exp_f32 v57, v57
    v_exp_f32 v58, v58
    v_exp_f32 v59, v59
    v_smfmac_f32_32x32x32_bf16 v[136:151], v[184:187], v[104:111], v196
    ds_read_b128 v[176:179], v2 offset:2048
    v_exp_f32 v60, v60
    v_exp_f32 v61, v61
    v_exp_f32 v62, v62
    v_smfmac_f32_16x16x64_bf16 v[156:159], v[192:195], v[104:111], v196
    v_exp_f32 v63, v63
    v_mfma_f32_32x32x16_bf16 v[88:103], v[172:175], v[12:15], v[88:103]
    v_exp_f32 v64, v64
    v_exp_f32 v65, v65
    v_exp_f32 v66, v66
    v_exp_f32 v67, v67
    v_smfmac_f32_32x32x32_bf16 v[136:151], v[188:191], v[112:119], v196
    ds_read_b128 v[180:183], v2 offset:3072
    v_exp_f32 v68, v68
    v_exp_f32 v69, v69
    v_exp_f32 v70, v70
    v_smfmac_f32_16x16x64_bf16 v[156:159], v[192:195], v[112:119], v196
    v_exp_f32 v71, v71
    s_waitcnt lgkmcnt(0)
    v_mfma_f32_32x32x16_bf16 v[104:119], v[168:171], v[16:19], v[40:55]
    v_exp_f32 v72, v72
    v_exp_f32 v73, v73
    v_exp_f32 v74, v74
    v_exp_f32 v75, v75
    v_smfmac_f32_32x32x32_bf16 v[120:135], v[176:179], v[56:63], v196
    ds_read_b128 v[160:163], v2 offset:8192
    v_exp_f32 v76, v76
    v_exp_f32 v77, v77
    v_exp_f32 v78, v78
    v_smfmac_f32_16x16x64_bf16 v[152:155], v[192:195], v[56:63], v196
    v_exp_f32 v79, v79
    v_mfma_f32_32x32x16_bf16 v[104:119], v[172:175], v[20:23], v[104:119]
    v_exp_f32 v80, v80
    v_exp_f32 v81, v81
    v_exp_f32 v82, v82
    v_exp_f32 v83, v83
    v_smfmac_f32_32x32x32_bf16 v[120:135], v[180:183], v[64:71], v196
    ds_read_b128 v[164:167], v2 offset:9216
    v_exp_f32 v84, v84
    v_exp_f32 v85, v85
    v_exp_f32 v86, v86
    v_smfmac_f32_16x16x64_bf16 v[152:155], v[192:195], v[64:71], v196
    v_exp_f32 v87, v87
    s_waitcnt lgkmcnt(0)
    v_mfma_f32_32x32x16_bf16 v[56:71], v[160:163], v[8:11], v[24:39]
    v_exp_f32 v88, v88
    v_exp_f32 v89, v89
    v_exp_f32 v90, v90
    v_exp_f32 v91, v91
    v_smfmac_f32_32x32x32_bf16 v[136:151], v[176:179], v[72:79], v196
    ds_read_b128 v[184:187], v2 offset:6144
    v_exp_f32 v92, v92
    v_exp_f32 v93, v93
    v_exp_f32 v94, v94
    v_smfmac_f32_16x16x64_bf16 v[156:159], v[192:195], v[72:79], v196
    v_exp_f32 v95, v95
    v_mfma_f32_32x32x16_bf16 v[56:71], v[164:167], v[12:15], v[56:71]
    v_exp_f32 v96, v96
    v_exp_f32 v97, v97
    v_exp_f32 v98, v98
    v_exp_f32 v99, v99
    v_smfmac_f32_32x32x32_bf16 v[136:151], v[180:183], v[80:87], v196
    ds_read_b128 v[188:191], v2 offset:7168
    v_exp_f32 v100, v100
    v_exp_f32 v101, v101
    v_exp_f32 v102, v102
    v_smfmac_f32_16x16x64_bf16 v[156:159], v[192:195], v[80:87], v196
    v_exp_f32 v103, v103
    s_waitcnt lgkmcnt(0)
    v_mfma_f32_32x32x16_bf16 v[72:87], v[160:163], v[16:19], v[40:55]
    v_exp_f32 v104, v104
    v_exp_f32 v105, v105
    v_exp_f32 v106, v106
    v_exp_f32 v107, v107
    v_smfmac_f32_32x32x32_bf16 v[120:135], v[184:187], v[88:95], v196
    ds_read_b128 v[168:171], v2 offset:12288
    v_exp_f32 v108, v108
    v_exp_f32 v109, v109
    v_exp_f32 v110, v110
    v_smfmac_f32_16x16x64_bf16 v[152:155], v[192:195], v[88:95], v196
    v_exp_f32 v111, v111
    v_mfma_f32_32x32x16_bf16 v[72:87], v[164:167], v[20:23], v[72:87]
    v_exp_f32 v112, v112
    v_exp_f32 v113, v113
    v_exp_f32 v114, v114
    v_exp_f32 v115, v115
    v_smfmac_f32_32x32x32_bf16 v[120:135], v[188:191], v[96:103], v196
    ds_read_b128 v[172:175], v2 offset:13312
    v_exp_f32 v116, v116
    v_exp_f32 v117, v117
    v_exp_f32 v118, v118
    v_smfmac_f32_16x16x64_bf16 v[152:155], v[192:195], v[96:103], v196
    v_exp_f32 v119, v119
    s_cmp_eq_u32 s34, 0
    s_cbranch_scc1 attn_w1
attn_w1d:
    s_barrier
    s_waitcnt lgkmcnt(0)
    v_mfma_f32_32x32x16_bf16 v[88:103], v[168:171], v[8:11], v[24:39]
    v_exp_f32 v56, v56
    v_exp_f32 v57, v57
    v_exp_f32 v58, v58
    v_exp_f32 v59, v59
    v_smfmac_f32_32x32x32_bf16 v[136:151], v[184:187], v[104:111], v196
    ds_read_b128 v[176:179], v2 offset:10240
    v_exp_f32 v60, v60
    v_exp_f32 v61, v61
    v_exp_f32 v62, v62
    v_smfmac_f32_16x16x64_bf16 v[156:159], v[192:195], v[104:111], v196
    v_exp_f32 v63, v63
    v_mfma_f32_32x32x16_bf16 v[88:103], v[172:175], v[12:15], v[88:103]
    v_exp_f32 v64, v64
    v_exp_f32 v65, v65
    v_exp_f32 v66, v66
    v_exp_f32 v67, v67
    v_smfmac_f32_32x32x32_bf16 v[136:151], v[188:191], v[112:119], v196
    ds_read_b128 v[180:183], v2 offset:11264
    v_exp_f32 v68, v68
    v_exp_f32 v69, v69
    v_exp_f32 v70, v70
    v_smfmac_f32_16x16x64_bf16 v[156:159], v[192:195], v[112:119], v196
    v_exp_f32 v71, v71
    s_waitcnt lgkmcnt(0)
    v_mfma_f32_32x32x16_bf16 v[104:119], v[168:171], v[16:19], v[40:55]
    v_exp_f32 v72, v72
    v_exp_f32 v73, v73
    v_exp_f32 v74, v74
    v_exp_f32 v75, v75
    v_smfmac_f32_32x32x32_bf16 v[120:135], v[176:179], v[56:63], v196
    ds_read_b128 v[160:163], v3 offset:0
    v_exp_f32 v76, v76
    v_exp_f32 v77, v77
    v_exp_f32 v78, v78
    v_smfmac_f32_16x16x64_bf16 v[152:155], v[192:195], v[56:63], v196
    v_exp_f32 v79, v79
    v_mfma_f32_32x32x16_bf16 v[104:119], v[172:175], v[20:23], v[104:119]
    v_exp_f32 v80, v80
    v_exp_f32 v81, v81
    v_exp_f32 v82, v82
    v_exp_f32 v83, v83
    v_smfmac_f32_32x32x32_bf16 v[120:135], v[180:183], v[64:71], v196
    ds_read_b128 v[164:167], v3 offset:1024
    v_exp_f32 v84, v84
    v_exp_f32 v85, v85
    v_exp_f32 v86, v86
    v_smfmac_f32_16x16x64_bf16 v[152:155], v[192:195], v[64:71], v196
    v_exp_f32 v87, v87
    s_waitcnt lgkmcnt(0)
    v_mfma_f32_32x32x16_bf16 v[56:71], v[160:163], v[8:11], v[24:39]
    v_exp_f32 v88, v88
    v_exp_f32 v89, v89
    v_exp_f32 v90, v90
    v_exp_f32 v91, v91
    v_smfmac_f32_32x32x32_bf16 v[136:151], v[176:179], v[72:79], v196
    ds_read_b128 v[184:187], v2 offset:14336
    v_exp_f32 v92, v92
    v_exp_f32 v93, v93
    v_exp_f32 v94, v94
    v_smfmac_f32_16x16x64_bf16 v[156:159], v[192:195], v[72:79], v196
    v_exp_f32 v95, v95
    v_mfma_f32_32x32x16_bf16 v[56:71], v[164:167], v[12:15], v[56:71]
    v_exp_f32 v96, v96
    v_exp_f32 v97, v97
    v_exp_f32 v98, v98
    v_exp_f32 v99, v99
    v_smfmac_f32_32x32x32_bf16 v[136:151], v[180:183], v[80:87], v196
    ds_read_b128 v[188:191], v2 offset:15360
    s_mov_b32 m0, s77
    s_add_u32 s37, s70, s76
    buffer_load_dwordx4 v198, s[20:23], s70 offen nt lds
    s_add_u32 m0, s77, 1024
    s_add_u32 s70, s70, s71
    buffer_load_dwordx4 v198, s[20:23], s37 offen nt lds
    s_add_u32 s77, s77, 2048
    v_exp_f32 v100, v100
    v_exp_f32 v101, v101
    v_exp_f32 v102, v102
    v_smfmac_f32_16x16x64_bf16 v[156:159], v[192:195], v[80:87], v196
    v_exp_f32 v103, v103
    s_waitcnt lgkmcnt(0)
    v_mfma_f32_32x32x16_bf16 v[72:87], v[160:163], v[16:19], v[40:55]
    v_exp_f32 v104, v104
    v_exp_f32 v105, v105
    v_exp_f32 v106, v106
    v_exp_f32 v107, v107
    v_smfmac_f32_32x32x32_bf16 v[120:135], v[184:187], v[88:95], v196
    ds_read_b128 v[168:171], v3 offset:4096
    v_exp_f32 v108, v108
    v_exp_f32 v109, v109
    v_exp_f32 v110, v110
    v_smfmac_f32_16x16x64_bf16 v[152:155], v[192:195], v[88:95], v196
    v_exp_f32 v111, v111
    v_mfma_f32_32x32x16_bf16 v[72:87], v[164:167], v[20:23], v[72:87]
    v_exp_f32 v112, v112
    v_exp_f32 v113, v113
    v_exp_f32 v114, v114
    v_exp_f32 v115, v115
    v_smfmac_f32_32x32x32_bf16 v[120:135], v[188:191], v[96:103], v196
    ds_read_b128 v[172:175], v3 offset:5120
    s_mov_b32 m0, s77
    s_add_u32 s37, s70, s76
    buffer_load_dwordx4 v198, s[20:23], s70 offen nt lds
    s_add_u32 m0, s77, 1024
    s_add_u32 s70, s70, s71
    buffer_load_dwordx4 v198, s[20:23], s37 offen nt lds
    s_add_u32 s77, s77, 2048
    s_add_u32 s41, s41, 32768
    s_cmp_ge_u32 s41, 98304
    s_cselect_b32 s41, 0, s41
    s_add_u32 s38, s41, 32768
    s_cmp_ge_u32 s38, 98304
    s_cselect_b32 s38, 0, s38
    v_mov_b32 v2, v3
    v_add_u32 v3, s38, v5
    s_add_u32 s34, s34, 1
    s_cmp_lt_u32 s34, 4
    v_exp_f32 v116, v116
    v_exp_f32 v117, v117
    v_exp_f32 v118, v118
    v_smfmac_f32_16x16x64_bf16 v[152:155], v[192:195], v[96:103], v196
    v_exp_f32 v119, v119
    s_cbranch_scc1 attn_loop2
.p2align 3
attn_loop3:
    s_waitcnt lgkmcnt(0)
    v_mfma_f32_32x32x16_bf16 v[88:103], v[168:171], v[8:11], v[24:39]
    v_exp_f32 v56, v56
    v_exp_f32 v57, v57
    v_exp_f32 v58, v58
    v_exp_f32 v59, v59
    v_smfmac_f32_32x32x32_bf16 v[136:151], v[184:187], v[104:111], v196
    ds_read_b128 v[176:179], v2 offset:2048
    v_exp_f32 v60, v60
    v_exp_f32 v61, v61
    v_exp_f32 v62, v62
    v_smfmac_f32_16x16x64_bf16 v[156:159], v[192:195], v[104:111], v196
    v_exp_f32 v63, v63
    v_mfma_f32_32x32x16_bf16 v[88:103], v[172:175], v[12:15], v[88:103]
    v_exp_f32 v64, v64
    v_exp_f32 v65, v65
    v_exp_f32 v66, v66
    v_exp_f32 v67, v67
    v_smfmac_f32_32x32x32_bf16 v[136:151], v[188:191], v[112:119], v196
    ds_read_b128 v[180:183], v2 offset:3072
    s_waitcnt vmcnt(12)
    ds_read_b64_tr_b16 v[204:205], v199 offset:0
    ds_read_b64_tr_b16 v[206:207], v200 offset:0
    ds_read_b64_tr_b16 v[208:209], v202 offset:0
    ds_read_b64_tr_b16 v[210:211], v203 offset:0
    v_exp_f32 v68, v68
    v_exp_f32 v69, v69
    v_exp_f32 v70, v70
    v_smfmac_f32_16x16x64_bf16 v[156:159], v[192:195], v[112:119], v196
    v_exp_f32 v71, v71
    s_waitcnt lgkmcnt(0)
    v_mfma_f32_32x32x16_bf16 v[104:119], v[168:171], v[16:19], v[40:55]
    v_exp_f32 v72, v72
    v_exp_f32 v73, v73
    v_exp_f32 v74, v74
    v_exp_f32 v75, v75
    v_smfmac_f32_32x32x32_bf16 v[120:135], v[176:179], v[56:63], v196
    ds_read_b128 v[160:163], v2 offset:8192
    v_exp_f32 v76, v76
    v_exp_f32 v77, v77
    v_exp_f32 v78, v78
    v_smfmac_f32_16x16x64_bf16 v[152:155], v[192:195], v[56:63], v196
    v_exp_f32 v79, v79
    v_mfma_f32_32x32x16_bf16 v[104:119], v[172:175], v[20:23], v[104:119]
    v_exp_f32 v80, v80
    v_exp_f32 v81, v81
    v_exp_f32 v82, v82
    v_exp_f32 v83, v83
    v_smfmac_f32_32x32x32_bf16 v[120:135], v[180:183], v[64:71], v196
    ds_read_b128 v[164:167], v2 offset:9216
    v_exp_f32 v84, v84
    v_exp_f32 v85, v85
    v_exp_f32 v86, v86
    v_smfmac_f32_16x16x64_bf16 v[152:155], v[192:195], v[64:71], v196
    v_exp_f32 v87, v87
    s_waitcnt lgkmcnt(0)
    v_mfma_f32_32x32x16_bf16 v[56:71], v[160:163], v[8:11], v[24:39]
    v_exp_f32 v88, v88
    v_exp_f32 v89, v89
    v_exp_f32 v90, v90
    v_exp_f32 v91, v91
    v_smfmac_f32_32x32x32_bf16 v[136:151], v[176:179], v[72:79], v196
    ds_read_b128 v[184:187], v2 offset:6144
    v_exp_f32 v92, v92
    v_exp_f32 v93, v93
    v_exp_f32 v94, v94
    v_smfmac_f32_16x16x64_bf16 v[156:159], v[192:195], v[72:79], v196
    v_exp_f32 v95, v95
    v_mfma_f32_32x32x16_bf16 v[56:71], v[164:167], v[12:15], v[56:71]
    v_exp_f32 v96, v96
    v_exp_f32 v97, v97
    v_exp_f32 v98, v98
    v_exp_f32 v99, v99
    v_smfmac_f32_32x32x32_bf16 v[136:151], v[180:183], v[80:87], v196
    ds_read_b128 v[188:191], v2 offset:7168
    s_add_u32 s37, s72, s75
    buffer_store_dwordx4 v[204:207], v4, s[24:27], s72 offen sc1
    buffer_store_dwordx4 v[208:211], v4, s[24:27], s37 offen sc1
    v_mfma_f32_16x16x32_bf16 v[212:215], v[204:207], v[220:223], v[212:215]
    v_mfma_f32_16x16x32_bf16 v[216:219], v[208:211], v[220:223], v[216:219]
    s_add_u32 s72, s72, s73
    s_mov_b32 s37, s73
    s_mov_b32 s73, s74
    s_mov_b32 s74, s37
    v_exp_f32 v100, v100
    v_exp_f32 v101, v101
    v_exp_f32 v102, v102
    v_smfmac_f32_16x16x64_bf16 v[156:159], v[192:195], v[80:87], v196
    v_exp_f32 v103, v103
    s_waitcnt lgkmcnt(0)
    v_mfma_f32_32x32x16_bf16 v[72:87], v[160:163], v[16:19], v[40:55]
    v_exp_f32 v104, v104
    v_exp_f32 v105, v105
    v_exp_f32 v106, v106
    v_exp_f32 v107, v107
    v_smfmac_f32_32x32x32_bf16 v[120:135], v[184:187], v[88:95], v196
    ds_read_b128 v[168:171], v2 offset:12288
    v_exp_f32 v108, v108
    v_exp_f32 v109, v109
    v_exp_f32 v110, v110
    v_smfmac_f32_16x16x64_bf16 v[152:155], v[192:195], v[88:95], v196
    v_exp_f32 v111, v111
    v_mfma_f32_32x32x16_bf16 v[72:87], v[164:167], v[20:23], v[72:87]
    v_exp_f32 v112, v112
    v_exp_f32 v113, v113
    v_exp_f32 v114, v114
    v_exp_f32 v115, v115
    v_smfmac_f32_32x32x32_bf16 v[120:135], v[188:191], v[96:103], v196
    ds_read_b128 v[172:175], v2 offset:13312
    v_exp_f32 v116, v116
    v_exp_f32 v117, v117
    v_exp_f32 v118, v118
    v_smfmac_f32_16x16x64_bf16 v[152:155], v[192:195], v[96:103], v196
    v_exp_f32 v119, v119
    s_barrier
    s_waitcnt lgkmcnt(0)
    v_mfma_f32_32x32x16_bf16 v[88:103], v[168:171], v[8:11], v[24:39]
    v_exp_f32 v56, v56
    v_exp_f32 v57, v57
    v_exp_f32 v58, v58
    v_exp_f32 v59, v59
    v_smfmac_f32_32x32x32_bf16 v[136:151], v[184:187], v[104:111], v196
    ds_read_b128 v[176:179], v2 offset:10240
    v_exp_f32 v60, v60
    v_exp_f32 v61, v61
    v_exp_f32 v62, v62
    v_smfmac_f32_16x16x64_bf16 v[156:159], v[192:195], v[104:111], v196
    v_exp_f32 v63, v63
    v_mfma_f32_32x32x16_bf16 v[88:103], v[172:175], v[12:15], v[88:103]
    v_exp_f32 v64, v64
    v_exp_f32 v65, v65
    v_exp_f32 v66, v66
    v_exp_f32 v67, v67
    v_smfmac_f32_32x32x32_bf16 v[136:151], v[188:191], v[112:119], v196
    ds_read_b128 v[180:183], v2 offset:11264
    ds_read_b64_tr_b16 v[204:205], v199 offset:2048
    ds_read_b64_tr_b16 v[206:207], v200 offset:2048
    ds_read_b64_tr_b16 v[208:209], v202 offset:2048
    ds_read_b64_tr_b16 v[210:211], v203 offset:2048
    v_exp_f32 v68, v68
    v_exp_f32 v69, v69
    v_exp_f32 v70, v70
    v_smfmac_f32_16x16x64_bf16 v[156:159], v[192:195], v[112:119], v196
    v_exp_f32 v71, v71
    s_waitcnt lgkmcnt(0)
    v_mfma_f32_32x32x16_bf16 v[104:119], v[168:171], v[16:19], v[40:55]
    v_exp_f32 v72, v72
    v_exp_f32 v73, v73
    v_exp_f32 v74, v74
    v_exp_f32 v75, v75
    v_smfmac_f32_32x32x32_bf16 v[120:135], v[176:179], v[56:63], v196
    ds_read_b128 v[160:163], v3 offset:0
    v_exp_f32 v76, v76
    v_exp_f32 v77, v77
    v_exp_f32 v78, v78
    v_smfmac_f32_16x16x64_bf16 v[152:155], v[192:195], v[56:63], v196
    v_exp_f32 v79, v79
    v_mfma_f32_32x32x16_bf16 v[104:119], v[172:175], v[20:23], v[104:119]
    v_exp_f32 v80, v80
    v_exp_f32 v81, v81
    v_exp_f32 v82, v82
    v_exp_f32 v83, v83
    v_smfmac_f32_32x32x32_bf16 v[120:135], v[180:183], v[64:71], v196
    ds_read_b128 v[164:167], v3 offset:1024
    v_exp_f32 v84, v84
    v_exp_f32 v85, v85
    v_exp_f32 v86, v86
    v_smfmac_f32_16x16x64_bf16 v[152:155], v[192:195], v[64:71], v196
    v_exp_f32 v87, v87
    s_waitcnt lgkmcnt(0)
    v_mfma_f32_32x32x16_bf16 v[56:71], v[160:163], v[8:11], v[24:39]
    v_exp_f32 v88, v88
    v_exp_f32 v89, v89
    v_exp_f32 v90, v90
    v_exp_f32 v91, v91
    v_smfmac_f32_32x32x32_bf16 v[136:151], v[176:179], v[72:79], v196
    ds_read_b128 v[184:187], v2 offset:14336
    v_exp_f32 v92, v92
    v_exp_f32 v93, v93
    v_exp_f32 v94, v94
    v_smfmac_f32_16x16x64_bf16 v[156:159], v[192:195], v[72:79], v196
    v_exp_f32 v95, v95
    v_mfma_f32_32x32x16_bf16 v[56:71], v[164:167], v[12:15], v[56:71]
    v_exp_f32 v96, v96
    v_exp_f32 v97, v97
    v_exp_f32 v98, v98
    v_exp_f32 v99, v99
    v_smfmac_f32_32x32x32_bf16 v[136:151], v[180:183], v[80:87], v196
    ds_read_b128 v[188:191], v2 offset:15360
    s_add_u32 s37, s72, s75
    buffer_store_dwordx4 v[204:207], v4, s[24:27], s72 offen sc1
    buffer_store_dwordx4 v[208:211], v4, s[24:27], s37 offen sc1
    v_mfma_f32_16x16x32_bf16 v[212:215], v[204:207], v[220:223], v[212:215]
    v_mfma_f32_16x16x32_bf16 v[216:219], v[208:211], v[220:223], v[216:219]
    s_add_u32 s72, s72, s73
    s_mov_b32 s37, s73
    s_mov_b32 s73, s74
    s_mov_b32 s74, s37
    v_add_u32 v199, 4096, v199
    v_add_u32 v200, 4096, v200
    v_add_u32 v202, 4096, v202
    v_add_u32 v203, 4096, v203
    v_exp_f32 v100, v100
    v_exp_f32 v101, v101
    v_exp_f32 v102, v102
    v_smfmac_f32_16x16x64_bf16 v[156:159], v[192:195], v[80:87], v196
    v_exp_f32 v103, v103
    s_waitcnt lgkmcnt(0)
    v_mfma_f32_32x32x16_bf16 v[72:87], v[160:163], v[16:19], v[40:55]
    v_exp_f32 v104, v104
    v_exp_f32 v105, v105
    v_exp_f32 v106, v106
    v_exp_f32 v107, v107
    v_smfmac_f32_32x32x32_bf16 v[120:135], v[184:187], v[88:95], v196
    ds_read_b128 v[168:171], v3 offset:4096
    v_exp_f32 v108, v108
    v_exp_f32 v109, v109
    v_exp_f32 v110, v110
    v_smfmac_f32_16x16x64_bf16 v[152:155], v[192:195], v[88:95], v196
    v_exp_f32 v111, v111
    v_mfma_f32_32x32x16_bf16 v[72:87], v[164:167], v[20:23], v[72:87]
    v_exp_f32 v112, v112
    v_exp_f32 v113, v113
    v_exp_f32 v114, v114
    v_exp_f32 v115, v115
    v_smfmac_f32_32x32x32_bf16 v[120:135], v[188:191], v[96:103], v196
    ds_read_b128 v[172:175], v3 offset:5120
    s_add_u32 s41, s41, 32768
    s_cmp_ge_u32 s41, 98304
    s_cselect_b32 s41, 0, s41
    s_add_u32 s38, s41, 32768
    s_cmp_ge_u32 s38, 98304
    s_cselect_b32 s38, 0, s38
    v_mov_b32 v2, v3
    v_add_u32 v3, s38, v5
    s_add_u32 s34, s34, 1
    s_cmp_lt_u32 s34, 8
    v_exp_f32 v116, v116
    v_exp_f32 v117, v117
    v_exp_f32 v118, v118
    v_smfmac_f32_16x16x64_bf16 v[152:155], v[192:195], v[96:103], v196
    v_exp_f32 v119, v119
    s_cbranch_scc1 attn_loop3
    s_branch attn_ld
.p2align 3
attn_loop1:
    s_waitcnt lgkmcnt(0)
    v_mfma_f32_32x32x16_bf16 v[88:103], v[168:171], v[8:11], v[24:39]
    v_exp_f32 v56, v56
    v_exp_f32 v57, v57
    v_exp_f32 v58, v58
    v_exp_f32 v59, v59
    v_smfmac_f32_32x32x32_bf16 v[136:151], v[184:187], v[104:111], v196
    ds_read_b128 v[176:179], v2 offset:2048
    v_exp_f32 v60, v60
    v_exp_f32 v61, v61
    v_exp_f32 v62, v62
    v_smfmac_f32_16x16x64_bf16 v[156:159], v[192:195], v[104:111], v196
    v_exp_f32 v63, v63
    v_mfma_f32_32x32x16_bf16 v[88:103], v[172:175], v[12:15], v[88:103]
    v_exp_f32 v64, v64
    v_exp_f32 v65, v65
    v_exp_f32 v66, v66
    v_exp_f32 v67, v67
    v_smfmac_f32_32x32x32_bf16 v[136:151], v[188:191], v[112:119], v196
    ds_read_b128 v[180:183], v2 offset:3072
    v_exp_f32 v68, v68
    v_exp_f32 v69, v69
    v_exp_f32 v70, v70
    v_smfmac_f32_16x16x64_bf16 v[156:159], v[192:195], v[112:119], v196
    v_exp_f32 v71, v71
    s_waitcnt lgkmcnt(0)
    v_mfma_f32_32x32x16_bf16 v[104:119], v[168:171], v[16:19], v[40:55]
    v_exp_f32 v72, v72
    v_exp_f32 v73, v73
    v_exp_f32 v74, v74
    v_exp_f32 v75, v75
    v_smfmac_f32_32x32x32_bf16 v[120:135], v[176:179], v[56:63], v196
    ds_read_b128 v[160:163], v2 offset:8192
    v_exp_f32 v76, v76
    v_exp_f32 v77, v77
    v_exp_f32 v78, v78
    v_smfmac_f32_16x16x64_bf16 v[152:155], v[192:195], v[56:63], v196
    v_exp_f32 v79, v79
    v_mfma_f32_32x32x16_bf16 v[104:119], v[172:175], v[20:23], v[104:119]
    v_exp_f32 v80, v80
    v_exp_f32 v81, v81
    v_exp_f32 v82, v82
    v_exp_f32 v83, v83
    v_smfmac_f32_32x32x32_bf16 v[120:135], v[180:183], v[64:71], v196
    ds_read_b128 v[164:167], v2 offset:9216
    v_exp_f32 v84, v84
    v_exp_f32 v85, v85
    v_exp_f32 v86, v86
    v_smfmac_f32_16x16x64_bf16 v[152:155], v[192:195], v[64:71], v196
    v_exp_f32 v87, v87
    s_waitcnt lgkmcnt(0)
    v_mfma_f32_32x32x16_bf16 v[56:71], v[160:163], v[8:11], v[24:39]
    v_exp_f32 v88, v88
    v_exp_f32 v89, v89
    v_exp_f32 v90, v90
    v_exp_f32 v91, v91
    v_smfmac_f32_32x32x32_bf16 v[136:151], v[176:179], v[72:79], v196
    ds_read_b128 v[184:187], v2 offset:6144
    v_exp_f32 v92, v92
    v_exp_f32 v93, v93
    v_exp_f32 v94, v94
    v_smfmac_f32_16x16x64_bf16 v[156:159], v[192:195], v[72:79], v196
    v_exp_f32 v95, v95
    v_mfma_f32_32x32x16_bf16 v[56:71], v[164:167], v[12:15], v[56:71]
    v_exp_f32 v96, v96
    v_exp_f32 v97, v97
    v_exp_f32 v98, v98
    v_exp_f32 v99, v99
    v_smfmac_f32_32x32x32_bf16 v[136:151], v[180:183], v[80:87], v196
    ds_read_b128 v[188:191], v2 offset:7168
    v_exp_f32 v100, v100
    v_exp_f32 v101, v101
    v_exp_f32 v102, v102
    v_smfmac_f32_16x16x64_bf16 v[156:159], v[192:195], v[80:87], v196
    v_exp_f32 v103, v103
    s_waitcnt lgkmcnt(0)
    v_mfma_f32_32x32x16_bf16 v[72:87], v[160:163], v[16:19], v[40:55]
    v_exp_f32 v104, v104
    v_exp_f32 v105, v105
    v_exp_f32 v106, v106
    v_exp_f32 v107, v107
    v_smfmac_f32_32x32x32_bf16 v[120:135], v[184:187], v[88:95], v196
    ds_read_b128 v[168:171], v2 offset:12288
    v_exp_f32 v108, v108
    v_exp_f32 v109, v109
    v_exp_f32 v110, v110
    v_smfmac_f32_16x16x64_bf16 v[152:155], v[192:195], v[88:95], v196
    v_exp_f32 v111, v111
    v_mfma_f32_32x32x16_bf16 v[72:87], v[164:167], v[20:23], v[72:87]
    v_exp_f32 v112, v112
    v_exp_f32 v113, v113
    v_exp_f32 v114, v114
    v_exp_f32 v115, v115
    v_smfmac_f32_32x32x32_bf16 v[120:135], v[188:191], v[96:103], v196
    ds_read_b128 v[172:175], v2 offset:13312
    v_exp_f32 v116, v116
    v_exp_f32 v117, v117
    v_exp_f32 v118, v118
    v_smfmac_f32_16x16x64_bf16 v[152:155], v[192:195], v[96:103], v196
    v_exp_f32 v119, v119
    s_waitcnt vmcnt(0)
    s_barrier
    s_waitcnt lgkmcnt(0)
    v_mfma_f32_32x32x16_bf16 v[88:103], v[168:171], v[8:11], v[24:39]
    v_exp_f32 v56, v56
    v_exp_f32 v57, v57
    v_exp_f32 v58, v58
    v_exp_f32 v59, v59
    v_smfmac_f32_32x32x32_bf16 v[136:151], v[184:187], v[104:111], v196
    ds_read_b128 v[176:179], v2 offset:10240
    s_cmp_ge_u32 s34, 6
    s_cselect_b32 s39, 0x7f000000, s39
    s_add_u32 s37, s41, 65536
    s_sub_u32 s38, s37, 98304
    s_cmp_ge_u32 s37, 98304
    s_cselect_b32 s37, s38, s37
    s_add_u32 m0, s37, s40
    s_nop 0
    buffer_load_dwordx4 v4, s[12:15], s39 offen offset:0 sc1 lds
    buffer_load_dwordx4 v4, s[12:15], s39 offen offset:1024 sc1 lds
    v_exp_f32 v60, v60
    v_exp_f32 v61, v61
    v_exp_f32 v62, v62
    v_smfmac_f32_16x16x64_bf16 v[156:159], v[192:195], v[104:111], v196
    v_exp_f32 v63, v63
    v_mfma_f32_32x32x16_bf16 v[88:103], v[172:175], v[12:15], v[88:103]
    v_exp_f32 v64, v64
    v_exp_f32 v65, v65
    v_exp_f32 v66, v66
    v_exp_f32 v67, v67
    v_smfmac_f32_32x32x32_bf16 v[136:151], v[188:191], v[112:119], v196
    ds_read_b128 v[180:183], v2 offset:11264
    buffer_load_dwordx4 v4, s[12:15], s39 offen offset:2048 sc1 lds
    buffer_load_dwordx4 v4, s[12:15], s39 offen offset:3072 sc1 lds
    v_exp_f32 v68, v68
    v_exp_f32 v69, v69
    v_exp_f32 v70, v70
    v_smfmac_f32_16x16x64_bf16 v[156:159], v[192:195], v[112:119], v196
    v_exp_f32 v71, v71
    s_waitcnt lgkmcnt(0)
    v_mfma_f32_32x32x16_bf16 v[104:119], v[168:171], v[16:19], v[40:55]
    v_exp_f32 v72, v72
    v_exp_f32 v73, v73
    v_exp_f32 v74, v74
    v_exp_f32 v75, v75
    v_smfmac_f32_32x32x32_bf16 v[120:135], v[176:179], v[56:63], v196
    ds_read_b128 v[160:163], v3 offset:0
    s_add_u32 m0, m0, 16384
    s_add_u32 s39, s39, 131072
    buffer_load_dwordx4 v4, s[12:15], s39 offen offset:0 sc1 lds
    buffer_load_dwordx4 v4, s[12:15], s39 offen offset:1024 sc1 lds
    v_exp_f32 v76, v76
    v_exp_f32 v77, v77
    v_exp_f32 v78, v78
    v_smfmac_f32_16x16x64_bf16 v[152:155], v[192:195], v[56:63], v196
    v_exp_f32 v79, v79
    v_mfma_f32_32x32x16_bf16 v[104:119], v[172:175], v[20:23], v[104:119]
    v_exp_f32 v80, v80
    v_exp_f32 v81, v81
    v_exp_f32 v82, v82
    v_exp_f32 v83, v83
    v_smfmac_f32_32x32x32_bf16 v[120:135], v[180:183], v[64:71], v196
    ds_read_b128 v[164:167], v3 offset:1024
    buffer_load_dwordx4 v4, s[12:15], s39 offen offset:2048 sc1 lds
    buffer_load_dwordx4 v4, s[12:15], s39 offen offset:3072 sc1 lds
    s_sub_u32 s39, s39, 114688
    v_exp_f32 v84, v84
    v_exp_f32 v85, v85
    v_exp_f32 v86, v86
    v_smfmac_f32_16x16x64_bf16 v[152:155], v[192:195], v[64:71], v196
    v_exp_f32 v87, v87
    s_waitcnt lgkmcnt(0)
    v_mfma_f32_32x32x16_bf16 v[56:71], v[160:163], v[8:11], v[24:39]
    v_exp_f32 v88, v88
    v_exp_f32 v89, v89
    v_exp_f32 v90, v90
    v_exp_f32 v91, v91
    v_smfmac_f32_32x32x32_bf16 v[136:151], v[176:179], v[72:79], v196
    ds_read_b128 v[184:187], v2 offset:14336
    v_exp_f32 v92, v92
    v_exp_f32 v93, v93
    v_exp_f32 v94, v94
    v_smfmac_f32_16x16x64_bf16 v[156:159], v[192:195], v[72:79], v196
    v_exp_f32 v95, v95
    v_mfma_f32_32x32x16_bf16 v[56:71], v[164:167], v[12:15], v[56:71]
    v_exp_f32 v96, v96
    v_exp_f32 v97, v97
    v_exp_f32 v98, v98
    v_exp_f32 v99, v99
    v_smfmac_f32_32x32x32_bf16 v[136:151], v[180:183], v[80:87], v196
    ds_read_b128 v[188:191], v2 offset:15360
    v_exp_f32 v100, v100
    v_exp_f32 v101, v101
    v_exp_f32 v102, v102
    v_smfmac_f32_16x16x64_bf16 v[156:159], v[192:195], v[80:87], v196
    v_exp_f32 v103, v103
    s_waitcnt lgkmcnt(0)
    v_mfma_f32_32x32x16_bf16 v[72:87], v[160:163], v[16:19], v[40:55]
    v_exp_f32 v104, v104
    v_exp_f32 v105, v105
    v_exp_f32 v106, v106
    v_exp_f32 v107, v107
    v_smfmac_f32_32x32x32_bf16 v[120:135], v[184:187], v[88:95], v196
    ds_read_b128 v[168:171], v3 offset:4096
    v_exp_f32 v108, v108
    v_exp_f32 v109, v109
    v_exp_f32 v110, v110
    v_smfmac_f32_16x16x64_bf16 v[152:155], v[192:195], v[88:95], v196
    v_exp_f32 v111, v111
    v_mfma_f32_32x32x16_bf16 v[72:87], v[164:167], v[20:23], v[72:87]
    v_exp_f32 v112, v112
    v_exp_f32 v113, v113
    v_exp_f32 v114, v114
    v_exp_f32 v115, v115
    v_smfmac_f32_32x32x32_bf16 v[120:135], v[188:191], v[96:103], v196
    ds_read_b128 v[172:175], v3 offset:5120
    s_add_u32 s41, s41, 32768
    s_cmp_ge_u32 s41, 98304
    s_cselect_b32 s41, 0, s41
    s_add_u32 s38, s41, 32768
    s_cmp_ge_u32 s38, 98304
    s_cselect_b32 s38, 0, s38
    v_mov_b32 v2, v3
    v_add_u32 v3, s38, v5
    s_add_u32 s34, s34, 1
    s_cmp_lt_u32 s34, 8
    v_exp_f32 v116, v116
    v_exp_f32 v117, v117
    v_exp_f32 v118, v118
    v_smfmac_f32_16x16x64_bf16 v[152:155], v[192:195], v[96:103], v196
    v_exp_f32 v119, v119
    s_cbranch_scc1 attn_loop1
    s_waitcnt vmcnt(0)
attn_ld:
    s_nop 1
    v_smfmac_f32_32x32x32_bf16 v[136:151], v[184:187], v[104:111], v196
    v_smfmac_f32_32x32x32_bf16 v[136:151], v[188:191], v[112:119], v196
    v_smfmac_f32_16x16x64_bf16 v[156:159], v[192:195], v[104:111], v196
    v_smfmac_f32_16x16x64_bf16 v[156:159], v[192:195], v[112:119], v196
    s_waitcnt lgkmcnt(0)
    s_barrier
    s_cmp_lt_u32 s2, 112
    s_cbranch_scc0 attn_nocs
    s_cmp_eq_u32 s33, 1
    s_cbranch_scc0 attn_nocs
    v_lshrrev_b32 v7, 4, v0
    s_sub_u32 s37, 5, s47
    v_lshlrev_b32 v7, s37, v7
    s_lshl_b32 s85, s85, 1
    v_and_b32 v6, 1, v0
    v_cmp_eq_u32 vcc, 1, v6
    v_mul_lo_u32 v6, s85, v6
    v_add_u32 v7, v6, v7
    v_cndmask_b32 v204, v212, v216, vcc
    v_cndmask_b32 v205, v213, v217, vcc
    v_cndmask_b32 v206, v214, v218, vcc
    v_cndmask_b32 v207, v215, v219, vcc
    s_mov_b32 exec_lo, 0x30003
    s_mov_b32 exec_hi, 0x30003
    buffer_store_dwordx4 v[204:207], v7, s[80:83], s78 offen sc1
    s_mov_b64 exec, -1
attn_nocs:
    s_mul_i32 s37, s30, 5120
    s_xor_b32 s38, s30, 4
    s_mul_i32 s38, s38, 5120
    v_add_u32 v6, s37, v4
    v_add_u32 v7, s38, v4
    s_nop 7
    s_cmp_eq_u32 s33, 0
    s_cbranch_scc1 attn_kh0
    ds_write_b128 v6, v[120:123] offset:0
    ds_write_b128 v6, v[124:127] offset:1024
    ds_write_b128 v6, v[128:131] offset:2048
    ds_write_b128 v6, v[132:135] offset:3072
    ds_write_b128 v6, v[152:155] offset:4096
    s_nop 1
    v_mov_b32 v120, v136
    v_mov_b32 v121, v137
    v_mov_b32 v122, v138
    v_mov_b32 v123, v139
    v_mov_b32 v124, v140
    v_mov_b32 v125, v141
    v_mov_b32 v126, v142
    v_mov_b32 v127, v143
    v_mov_b32 v128, v144
    v_mov_b32 v129, v145
    v_mov_b32 v130, v146
    v_mov_b32 v131, v147
    v_mov_b32 v132, v148
    v_mov_b32 v133, v149
    v_mov_b32 v134, v150
    v_mov_b32 v135, v151
    v_mov_b32 v152, v156
    s_branch attn_khd
attn_kh0:
    ds_write_b128 v6, v[136:139] offset:0
    ds_write_b128 v6, v[140:143] offset:1024
    ds_write_b128 v6, v[144:147] offset:2048
    ds_write_b128 v6, v[148:151] offset:3072
    ds_write_b128 v6, v[156:159] offset:4096
attn_khd:
    v_mov_b32 v1, 0
    v_mov_b32 v197, 163776
    ds_write_b32 v197, v1
    s_waitcnt lgkmcnt(0)
    s_barrier
    ds_read_b128 v[56:59], v7 offset:0
    ds_read_b128 v[60:63], v7 offset:1024
    ds_read_b128 v[64:67], v7 offset:2048
    ds_read_b128 v[68:71], v7 offset:3072
    ds_read_b128 v[72:75], v7 offset:4096
    s_waitcnt lgkmcnt(0)
    v_add_f32 v152, v152, v72
    v_rcp_f32 v154, v152
    v_pk_add_f32 v[120:121], v[120:121], v[56:57]
    v_pk_add_f32 v[122:123], v[122:123], v[58:59]
    v_pk_add_f32 v[124:125], v[124:125], v[60:61]
    v_pk_add_f32 v[126:127], v[126:127], v[62:63]
    v_pk_add_f32 v[128:129], v[128:129], v[64:65]
    v_pk_add_f32 v[130:131], v[130:131], v[66:67]
    v_pk_add_f32 v[132:133], v[132:133], v[68:69]
    v_pk_add_f32 v[134:135], v[134:135], v[70:71]
    v_mov_b32 v155, v154
    v_pk_mul_f32 v[120:121], v[120:121], v[154:155]
    v_pk_mul_f32 v[122:123], v[122:123], v[154:155]
    v_pk_mul_f32 v[124:125], v[124:125], v[154:155]
    v_pk_mul_f32 v[126:127], v[126:127], v[154:155]
    v_pk_mul_f32 v[128:129], v[128:129], v[154:155]
    v_pk_mul_f32 v[130:131], v[130:131], v[154:155]
    v_pk_mul_f32 v[132:133], v[132:133], v[154:155]
    v_pk_mul_f32 v[134:135], v[134:135], v[154:155]
    v_cvt_pk_bf16_f32 v56, v120, v121
    v_cvt_pk_bf16_f32 v57, v122, v123
    v_cvt_pk_bf16_f32 v58, v124, v125
    v_cvt_pk_bf16_f32 v59, v126, v127
    v_cvt_pk_bf16_f32 v60, v128, v129
    v_cvt_pk_bf16_f32 v61, v130, v131
    v_cvt_pk_bf16_f32 v62, v132, v133
    v_cvt_pk_bf16_f32 v63, v134, v135
    s_add_u32 s37, s32, s33
    s_lshr_b32 s38, s37, 2
    s_lshl_b32 s38, s38, 18
    s_and_b32 s37, s37, 3
    s_lshl_b32 s37, s37, 12
    s_add_u32 s37, s37, s38
    s_lshr_b32 s38, s31, 1
    s_lshl_b32 s38, s38, 14
    s_add_u32 s37, s37, s38
    s_and_b32 s38, s31, 1
    s_lshl_b32 s38, s38, 10
    s_add_u32 s37, s37, s38
    v_and_b32 v6, 15, v0
    v_lshlrev_b32 v6, 4, v6
    v_bfe_u32 v7, v0, 4, 1
    v_lshl_add_u32 v6, v7, 11, v6
    v_lshrrev_b32 v7, 5, v0
    v_lshl_add_u32 v6, v7, 9, v6
    buffer_store_dwordx4 v[56:59], v6, s[16:19], s37 offen offset:0 sc1
    buffer_store_dwordx4 v[60:63], v6, s[16:19], s37 offen offset:256 sc1
    s_cmp_lg_u32 s36, 1
    s_cbranch_scc1 attn_ok
    v_fma_f32 v152, v120, 0, v152
    v_fma_f32 v152, v121, 0, v152
    v_fma_f32 v152, v122, 0, v152
    v_fma_f32 v152, v123, 0, v152
    v_fma_f32 v152, v124, 0, v152
    v_fma_f32 v152, v125, 0, v152
    v_fma_f32 v152, v126, 0, v152
    v_fma_f32 v152, v127, 0, v152
    v_fma_f32 v152, v128, 0, v152
    v_fma_f32 v152, v129, 0, v152
    v_fma_f32 v152, v130, 0, v152
    v_fma_f32 v152, v131, 0, v152
    v_fma_f32 v152, v132, 0, v152
    v_fma_f32 v152, v133, 0, v152
    v_fma_f32 v152, v134, 0, v152
    v_fma_f32 v152, v135, 0, v152
    v_mov_b32 v7, 0x5d800000
    v_cmp_nlt_f32 vcc, v152, v7
    s_nop 4
    s_cmp_eq_u64 vcc, 0
    s_cbranch_scc1 attn_ok
    v_mov_b32 v1, 1
    ds_write_b32 v197, v1
attn_ok:
    s_cmp_eq_u32 s33, 0
    s_cbranch_scc1 attn_pdw
    s_mov_b32 s56, s6
    s_mov_b32 s57, s7
    s_mov_b32 s58, 0x100
    s_mov_b32 s59, 0x20000
    s_mov_b32 s43, 4
    v_min_u32 v244, 3, v0
    v_lshlrev_b32 v244, 6, v244
    s_mov_b32 s87, 0x40000
    s_mov_b32 s86, 0x40
attn_plw:
    buffer_load_dword v240, v244, s[56:59], s43 offen sc1
    s_waitcnt vmcnt(0)
    v_cmp_ne_u32 vcc, s86, v240
    s_sub_u32 s87, s87, 1
    s_nop 3
    s_cbranch_vccz attn_pdw
    s_sleep 6
    s_cmp_lg_u32 s87, 0
    s_cbranch_scc1 attn_plw
attn_pdw:
    s_waitcnt vmcnt(0) lgkmcnt(0)
    s_barrier
    ds_read_b32 v1, v197
    s_waitcnt lgkmcnt(0)
    v_readfirstlane_b32 s37, v1
    s_nop 3
    s_cmp_eq_u32 s37, 0
    s_cbranch_scc1 attn_store
    s_mov_b32 s36, 64
    s_barrier
    s_branch attn_retry
attn_store:
    s_setprio 0
    s_add_u32 s43, s32, s33
    s_lshl_b32 s43, s43, 5
    s_add_u32 s43, s43, s31
    s_lshl_b32 s43, s43, 7
    s_add_u32 s43, s43, 131072
    v_lshlrev_b32 v240, 7, v0
    v_mov_b32 v241, 1
    s_waitcnt vmcnt(0)
    s_mov_b64 exec, 1
    buffer_store_dword v241, v240, s[88:91], s43 offen sc1
    s_mov_b64 exec, -1
    s_cmp_eq_u32 s30, 0
    s_cbranch_scc0 attn_nsj
    s_lshl_b32 s43, s2, 2
    s_add_u32 s43, s43, 655360
    s_mov_b64 exec, 1
    buffer_store_dword v241, v240, s[88:91], s43 offen sc1
    s_mov_b64 exec, -1
attn_nsj:
    s_mov_b32 s30, s29
    s_load_dwordx2 s[48:49], s[0:1], 0
    s_and_b32 s37, s2, 7
    s_lshr_b32 s38, s2, 3
    s_and_b32 s31, s37, 3
    s_lshl_b32 s31, s31, 2
    s_and_b32 s3, s38, 3
    s_add_u32 s31, s31, s3
    s_lshr_b32 s32, s37, 2
    s_lshl_b32 s32, s32, 3
    s_lshr_b32 s3, s38, 2
    s_add_u32 s32, s32, s3
    v_lshlrev_b32 v2, 4, v0
    s_cmp_lt_u32 s30, 4
    s_cbranch_scc1 oproj_cons
    s_add_u32 s12, s4, 0x3200000
    s_addc_u32 s13, s5, 0
    s_mov_b32 s14, 0x200000
    s_mov_b32 s15, 0x20000
    s_sub_u32 s41, s30, 4
    s_lshl_b32 s41, s41, 12
    s_lshl_b32 s42, s32, 17
    s_add_u32 s42, s42, s41
    s_mov_b32 m0, s41
    s_add_u32 s41, s41, 16384
    buffer_load_dwordx4 v2, s[12:15], s42 offen offset:0 sc1 lds
    buffer_load_dwordx4 v2, s[12:15], s42 offen offset:1024 sc1 lds
    buffer_load_dwordx4 v2, s[12:15], s42 offen offset:2048 sc1 lds
    buffer_load_dwordx4 v2, s[12:15], s42 offen offset:3072 sc1 lds
    s_add_u32 s42, s42, 16384
    s_mov_b32 m0, s41
    s_add_u32 s41, s41, 16384
    buffer_load_dwordx4 v2, s[12:15], s42 offen offset:0 sc1 lds
    buffer_load_dwordx4 v2, s[12:15], s42 offen offset:1024 sc1 lds
    buffer_load_dwordx4 v2, s[12:15], s42 offen offset:2048 sc1 lds
    buffer_load_dwordx4 v2, s[12:15], s42 offen offset:3072 sc1 lds
    s_add_u32 s42, s42, 16384
    s_mov_b32 m0, s41
    s_add_u32 s41, s41, 16384
    buffer_load_dwordx4 v2, s[12:15], s42 offen offset:0 sc1 lds
    buffer_load_dwordx4 v2, s[12:15], s42 offen offset:1024 sc1 lds
    buffer_load_dwordx4 v2, s[12:15], s42 offen offset:2048 sc1 lds
    buffer_load_dwordx4 v2, s[12:15], s42 offen offset:3072 sc1 lds
    s_add_u32 s42, s42, 16384
    s_mov_b32 m0, s41
    s_add_u32 s41, s41, 16384
    buffer_load_dwordx4 v2, s[12:15], s42 offen offset:0 sc1 lds
    buffer_load_dwordx4 v2, s[12:15], s42 offen offset:1024 sc1 lds
    buffer_load_dwordx4 v2, s[12:15], s42 offen offset:2048 sc1 lds
    buffer_load_dwordx4 v2, s[12:15], s42 offen offset:3072 sc1 lds
    s_add_u32 s42, s42, 16384
    s_mov_b32 m0, s41
    s_add_u32 s41, s41, 16384
    buffer_load_dwordx4 v2, s[12:15], s42 offen offset:0 sc1 lds
    buffer_load_dwordx4 v2, s[12:15], s42 offen offset:1024 sc1 lds
    buffer_load_dwordx4 v2, s[12:15], s42 offen offset:2048 sc1 lds
    buffer_load_dwordx4 v2, s[12:15], s42 offen offset:3072 sc1 lds
    s_add_u32 s42, s42, 16384
    s_waitcnt vmcnt(4)
    s_barrier
    s_mov_b32 m0, s41
    s_add_u32 s41, s41, 16384
    buffer_load_dwordx4 v2, s[12:15], s42 offen offset:0 sc1 lds
    buffer_load_dwordx4 v2, s[12:15], s42 offen offset:1024 sc1 lds
    buffer_load_dwordx4 v2, s[12:15], s42 offen offset:2048 sc1 lds
    buffer_load_dwordx4 v2, s[12:15], s42 offen offset:3072 sc1 lds
    s_add_u32 s42, s42, 16384
    s_mov_b32 m0, s41
    s_add_u32 s41, s41, 16384
    buffer_load_dwordx4 v2, s[12:15], s42 offen offset:0 sc1 lds
    buffer_load_dwordx4 v2, s[12:15], s42 offen offset:1024 sc1 lds
    buffer_load_dwordx4 v2, s[12:15], s42 offen offset:2048 sc1 lds
    buffer_load_dwordx4 v2, s[12:15], s42 offen offset:3072 sc1 lds
    s_add_u32 s42, s42, 16384
    s_mov_b32 m0, s41
    s_add_u32 s41, s41, 16384
    buffer_load_dwordx4 v2, s[12:15], s42 offen offset:0 sc1 lds
    buffer_load_dwordx4 v2, s[12:15], s42 offen offset:1024 sc1 lds
    buffer_load_dwordx4 v2, s[12:15], s42 offen offset:2048 sc1 lds
    buffer_load_dwordx4 v2, s[12:15], s42 offen offset:3072 sc1 lds
    s_add_u32 s42, s42, 16384
    s_waitcnt vmcnt(0)
    s_barrier
    s_barrier
    s_branch oproj_end
oproj_cons:
    s_mov_b32 s39, s30
    s_add_u32 s8, s4, 0x1000000
    s_addc_u32 s9, s5, 0
    s_mov_b32 s10, 0x400000
    s_mov_b32 s11, 0x20000
    s_lshl_b32 s35, s31, 18
    s_lshl_b32 s3, s39, 12
    s_add_u32 s35, s35, s3
    s_lshl_b32 s43, s31, 2
    s_add_u32 s43, s43, s39
    s_lshl_b32 s43, s43, 12
    s_add_u32 s43, s43, 131072
    v_add_u32 v3, 65536, v2
    s_waitcnt lgkmcnt(0)
    v_mov_b32 v8, 0
    v_mov_b32 v9, 0
    v_mov_b32 v10, 0
    v_mov_b32 v11, 0
    v_mov_b32 v12, 0
    v_mov_b32 v13, 0
    v_mov_b32 v14, 0
    v_mov_b32 v15, 0
    v_mov_b32 v16, 0
    v_mov_b32 v17, 0
    v_mov_b32 v18, 0
    v_mov_b32 v19, 0
    v_mov_b32 v20, 0
    v_mov_b32 v21, 0
    v_mov_b32 v22, 0
    v_mov_b32 v23, 0
    v_mov_b32 v24, 0
    v_mov_b32 v25, 0
    v_mov_b32 v26, 0
    v_mov_b32 v27, 0
    v_mov_b32 v28, 0
    v_mov_b32 v29, 0
    v_mov_b32 v30, 0
    v_mov_b32 v31, 0
    v_mov_b32 v32, 0
    v_mov_b32 v33, 0
    v_mov_b32 v34, 0
    v_mov_b32 v35, 0
    v_mov_b32 v36, 0
    v_mov_b32 v37, 0
    v_mov_b32 v38, 0
    v_mov_b32 v39, 0
    s_mov_b32 s20, s48
    s_mov_b32 s21, s49
    s_mov_b32 s22, 0x400000
    s_mov_b32 s23, 0x20000
    s_lshl_b32 s41, s31, 2
    s_add_u32 s41, s41, s39
    s_lshl_b32 s41, s41, 16
    s_lshl_b32 s3, s32, 7
    s_add_u32 s41, s41, s3
    s_add_u32 s42, s41, 32768
    v_and_b32 v7, 15, v0
    v_lshlrev_b32 v7, 11, v7
    v_lshrrev_b32 v1, 4, v0
    v_lshl_add_u32 v7, v1, 4, v7
    buffer_load_dwordx4 v[100:103], v7, s[20:23], s41 offen offset:0
    buffer_load_dwordx4 v[104:107], v7, s[20:23], s41 offen offset:64
    buffer_load_dwordx4 v[108:111], v7, s[20:23], s42 offen offset:0
    buffer_load_dwordx4 v[112:115], v7, s[20:23], s42 offen offset:64
    v_min_u32 v244, 31, v0
    v_lshlrev_b32 v244, 7, v244
    s_mov_b32 s87, 0x40000
    s_mov_b32 s86, 0x1
oproj_plx:
    buffer_load_dword v240, v244, s[88:91], s43 offen sc1
    s_waitcnt vmcnt(0)
    v_cmp_ne_u32 vcc, s86, v240
    s_sub_u32 s87, s87, 1
    s_nop 3
    s_cbranch_vccz oproj_pdx
    s_sleep 6
    s_cmp_lg_u32 s87, 0
    s_cbranch_scc1 oproj_plx
oproj_pdx:
    buffer_load_dwordx4 v[176:179], v2, s[8:11], s35 offen offset:0 sc1
    buffer_load_dwordx4 v[180:183], v2, s[8:11], s35 offen offset:2048 sc1
    buffer_load_dwordx4 v[184:187], v2, s[8:11], s35 offen offset:1024 sc1
    buffer_load_dwordx4 v[188:191], v2, s[8:11], s35 offen offset:3072 sc1
    s_add_u32 s35, s35, 16384
    buffer_load_dwordx4 v[192:195], v2, s[8:11], s35 offen offset:0 sc1
    buffer_load_dwordx4 v[196:199], v2, s[8:11], s35 offen offset:2048 sc1
    buffer_load_dwordx4 v[200:203], v2, s[8:11], s35 offen offset:1024 sc1
    buffer_load_dwordx4 v[204:207], v2, s[8:11], s35 offen offset:3072 sc1
    s_add_u32 s35, s35, 16384
    buffer_load_dwordx4 v[208:211], v2, s[8:11], s35 offen offset:0 sc1
    buffer_load_dwordx4 v[212:215], v2, s[8:11], s35 offen offset:2048 sc1
    buffer_load_dwordx4 v[216:219], v2, s[8:11], s35 offen offset:1024 sc1
    buffer_load_dwordx4 v[220:223], v2, s[8:11], s35 offen offset:3072 sc1
    s_add_u32 s35, s35, 16384
    buffer_load_dwordx4 v[224:227], v2, s[8:11], s35 offen offset:0 sc1
    buffer_load_dwordx4 v[228:231], v2, s[8:11], s35 offen offset:2048 sc1
    buffer_load_dwordx4 v[232:235], v2, s[8:11], s35 offen offset:1024 sc1
    buffer_load_dwordx4 v[236:239], v2, s[8:11], s35 offen offset:3072 sc1
    s_add_u32 s35, s35, 16384
    s_barrier
    ds_read_b128 v[40:43], v2 offset:0
    ds_read_b128 v[44:47], v2 offset:2048
    ds_read_b128 v[48:51], v2 offset:4096
    ds_read_b128 v[52:55], v2 offset:6144
    ds_read_b128 v[56:59], v2 offset:1024
    ds_read_b128 v[60:63], v2 offset:3072
    ds_read_b128 v[64:67], v2 offset:5120
    ds_read_b128 v[68:71], v2 offset:7168
    s_waitcnt vmcnt(14) lgkmcnt(4)
    v_mfma_f32_16x16x32_bf16 v[8:11], v[40:43], v[176:179], v[8:11]
    v_mfma_f32_16x16x32_bf16 v[24:27], v[40:43], v[180:183], v[24:27]
    v_mfma_f32_16x16x32_bf16 v[12:15], v[44:47], v[176:179], v[12:15]
    v_mfma_f32_16x16x32_bf16 v[28:31], v[44:47], v[180:183], v[28:31]
    v_mfma_f32_16x16x32_bf16 v[16:19], v[48:51], v[176:179], v[16:19]
    v_mfma_f32_16x16x32_bf16 v[32:35], v[48:51], v[180:183], v[32:35]
    v_mfma_f32_16x16x32_bf16 v[20:23], v[52:55], v[176:179], v[20:23]
    v_mfma_f32_16x16x32_bf16 v[36:39], v[52:55], v[180:183], v[36:39]
    buffer_load_dwordx4 v[176:179], v2, s[8:11], s35 offen offset:0 sc1
    buffer_load_dwordx4 v[180:183], v2, s[8:11], s35 offen offset:2048 sc1
    ds_read_b128 v[40:43], v2 offset:8192
    ds_read_b128 v[44:47], v2 offset:10240
    ds_read_b128 v[48:51], v2 offset:12288
    ds_read_b128 v[52:55], v2 offset:14336
    s_waitcnt vmcnt(14) lgkmcnt(4)
    v_mfma_f32_16x16x32_bf16 v[8:11], v[56:59], v[184:187], v[8:11]
    v_mfma_f32_16x16x32_bf16 v[24:27], v[56:59], v[188:191], v[24:27]
    v_mfma_f32_16x16x32_bf16 v[12:15], v[60:63], v[184:187], v[12:15]
    v_mfma_f32_16x16x32_bf16 v[28:31], v[60:63], v[188:191], v[28:31]
    v_mfma_f32_16x16x32_bf16 v[16:19], v[64:67], v[184:187], v[16:19]
    v_mfma_f32_16x16x32_bf16 v[32:35], v[64:67], v[188:191], v[32:35]
    v_mfma_f32_16x16x32_bf16 v[20:23], v[68:71], v[184:187], v[20:23]
    v_mfma_f32_16x16x32_bf16 v[36:39], v[68:71], v[188:191], v[36:39]
    buffer_load_dwordx4 v[184:187], v2, s[8:11], s35 offen offset:1024 sc1
    buffer_load_dwordx4 v[188:191], v2, s[8:11], s35 offen offset:3072 sc1
    s_add_u32 s35, s35, 16384
    ds_read_b128 v[56:59], v2 offset:9216
    ds_read_b128 v[60:63], v2 offset:11264
    ds_read_b128 v[64:67], v2 offset:13312
    ds_read_b128 v[68:71], v2 offset:15360
    s_waitcnt vmcnt(14) lgkmcnt(4)
    v_mfma_f32_16x16x32_bf16 v[8:11], v[40:43], v[192:195], v[8:11]
    v_mfma_f32_16x16x32_bf16 v[24:27], v[40:43], v[196:199], v[24:27]
    v_mfma_f32_16x16x32_bf16 v[12:15], v[44:47], v[192:195], v[12:15]
    v_mfma_f32_16x16x32_bf16 v[28:31], v[44:47], v[196:199], v[28:31]
    v_mfma_f32_16x16x32_bf16 v[16:19], v[48:51], v[192:195], v[16:19]
    v_mfma_f32_16x16x32_bf16 v[32:35], v[48:51], v[196:199], v[32:35]
    v_mfma_f32_16x16x32_bf16 v[20:23], v[52:55], v[192:195], v[20:23]
    v_mfma_f32_16x16x32_bf16 v[36:39], v[52:55], v[196:199], v[36:39]
    buffer_load_dwordx4 v[192:195], v2, s[8:11], s35 offen offset:0 sc1
    buffer_load_dwordx4 v[196:199], v2, s[8:11], s35 offen offset:2048 sc1
    ds_read_b128 v[40:43], v2 offset:16384
    ds_read_b128 v[44:47], v2 offset:18432
    ds_read_b128 v[48:51], v2 offset:20480
    ds_read_b128 v[52:55], v2 offset:22528
    s_waitcnt vmcnt(14) lgkmcnt(4)
    v_mfma_f32_16x16x32_bf16 v[8:11], v[56:59], v[200:203], v[8:11]
    v_mfma_f32_16x16x32_bf16 v[24:27], v[56:59], v[204:207], v[24:27]
    v_mfma_f32_16x16x32_bf16 v[12:15], v[60:63], v[200:203], v[12:15]
    v_mfma_f32_16x16x32_bf16 v[28:31], v[60:63], v[204:207], v[28:31]
    v_mfma_f32_16x16x32_bf16 v[16:19], v[64:67], v[200:203], v[16:19]
    v_mfma_f32_16x16x32_bf16 v[32:35], v[64:67], v[204:207], v[32:35]
    v_mfma_f32_16x16x32_bf16 v[20:23], v[68:71], v[200:203], v[20:23]
    v_mfma_f32_16x16x32_bf16 v[36:39], v[68:71], v[204:207], v[36:39]
    buffer_load_dwordx4 v[200:203], v2, s[8:11], s35 offen offset:1024 sc1
    buffer_load_dwordx4 v[204:207], v2, s[8:11], s35 offen offset:3072 sc1
    s_add_u32 s35, s35, 16384
    ds_read_b128 v[56:59], v2 offset:17408
    ds_read_b128 v[60:63], v2 offset:19456
    ds_read_b128 v[64:67], v2 offset:21504
    ds_read_b128 v[68:71], v2 offset:23552
    s_waitcnt vmcnt(14) lgkmcnt(4)
    v_mfma_f32_16x16x32_bf16 v[8:11], v[40:43], v[208:211], v[8:11]
    v_mfma_f32_16x16x32_bf16 v[24:27], v[40:43], v[212:215], v[24:27]
    v_mfma_f32_16x16x32_bf16 v[12:15], v[44:47], v[208:211], v[12:15]
    v_mfma_f32_16x16x32_bf16 v[28:31], v[44:47], v[212:215], v[28:31]
    v_mfma_f32_16x16x32_bf16 v[16:19], v[48:51], v[208:211], v[16:19]
    v_mfma_f32_16x16x32_bf16 v[32:35], v[48:51], v[212:215], v[32:35]
    v_mfma_f32_16x16x32_bf16 v[20:23], v[52:55], v[208:211], v[20:23]
    v_mfma_f32_16x16x32_bf16 v[36:39], v[52:55], v[212:215], v[36:39]
    buffer_load_dwordx4 v[208:211], v2, s[8:11], s35 offen offset:0 sc1
    buffer_load_dwordx4 v[212:215], v2, s[8:11], s35 offen offset:2048 sc1
    ds_read_b128 v[40:43], v2 offset:24576
    ds_read_b128 v[44:47], v2 offset:26624
    ds_read_b128 v[48:51], v2 offset:28672
    ds_read_b128 v[52:55], v2 offset:30720
    s_waitcnt vmcnt(14) lgkmcnt(4)
    v_mfma_f32_16x16x32_bf16 v[8:11], v[56:59], v[216:219], v[8:11]
    v_mfma_f32_16x16x32_bf16 v[24:27], v[56:59], v[220:223], v[24:27]
    v_mfma_f32_16x16x32_bf16 v[12:15], v[60:63], v[216:219], v[12:15]
    v_mfma_f32_16x16x32_bf16 v[28:31], v[60:63], v[220:223], v[28:31]
    v_mfma_f32_16x16x32_bf16 v[16:19], v[64:67], v[216:219], v[16:19]
    v_mfma_f32_16x16x32_bf16 v[32:35], v[64:67], v[220:223], v[32:35]
    v_mfma_f32_16x16x32_bf16 v[20:23], v[68:71], v[216:219], v[20:23]
    v_mfma_f32_16x16x32_bf16 v[36:39], v[68:71], v[220:223], v[36:39]
    buffer_load_dwordx4 v[216:219], v2, s[8:11], s35 offen offset:1024 sc1
    buffer_load_dwordx4 v[220:223], v2, s[8:11], s35 offen offset:3072 sc1
    s_add_u32 s35, s35, 16384
    ds_read_b128 v[56:59], v2 offset:25600
    ds_read_b128 v[60:63], v2 offset:27648
    ds_read_b128 v[64:67], v2 offset:29696
    ds_read_b128 v[68:71], v2 offset:31744
    s_waitcnt vmcnt(14) lgkmcnt(4)
    v_mfma_f32_16x16x32_bf16 v[8:11], v[40:43], v[224:227], v[8:11]
    v_mfma_f32_16x16x32_bf16 v[24:27], v[40:43], v[228:231], v[24:27]
    v_mfma_f32_16x16x32_bf16 v[12:15], v[44:47], v[224:227], v[12:15]
    v_mfma_f32_16x16x32_bf16 v[28:31], v[44:47], v[228:231], v[28:31]
    v_mfma_f32_16x16x32_bf16 v[16:19], v[48:51], v[224:227], v[16:19]
    v_mfma_f32_16x16x32_bf16 v[32:35], v[48:51], v[228:231], v[32:35]
    v_mfma_f32_16x16x32_bf16 v[20:23], v[52:55], v[224:227], v[20:23]
    v_mfma_f32_16x16x32_bf16 v[36:39], v[52:55], v[228:231], v[36:39]
    buffer_load_dwordx4 v[224:227], v2, s[8:11], s35 offen offset:0 sc1
    buffer_load_dwordx4 v[228:231], v2, s[8:11], s35 offen offset:2048 sc1
    ds_read_b128 v[40:43], v2 offset:32768
    ds_read_b128 v[44:47], v2 offset:34816
    ds_read_b128 v[48:51], v2 offset:36864
    ds_read_b128 v[52:55], v2 offset:38912
    s_waitcnt vmcnt(14) lgkmcnt(4)
    v_mfma_f32_16x16x32_bf16 v[8:11], v[56:59], v[232:235], v[8:11]
    v_mfma_f32_16x16x32_bf16 v[24:27], v[56:59], v[236:239], v[24:27]
    v_mfma_f32_16x16x32_bf16 v[12:15], v[60:63], v[232:235], v[12:15]
    v_mfma_f32_16x16x32_bf16 v[28:31], v[60:63], v[236:239], v[28:31]
    v_mfma_f32_16x16x32_bf16 v[16:19], v[64:67], v[232:235], v[16:19]
    v_mfma_f32_16x16x32_bf16 v[32:35], v[64:67], v[236:239], v[32:35]
    v_mfma_f32_16x16x32_bf16 v[20:23], v[68:71], v[232:235], v[20:23]
    v_mfma_f32_16x16x32_bf16 v[36:39], v[68:71], v[236:239], v[36:39]
    buffer_load_dwordx4 v[232:235], v2, s[8:11], s35 offen offset:1024 sc1
    buffer_load_dwordx4 v[236:239], v2, s[8:11], s35 offen offset:3072 sc1
    s_add_u32 s35, s35, 16384
    ds_read_b128 v[56:59], v2 offset:33792
    ds_read_b128 v[60:63], v2 offset:35840
    ds_read_b128 v[64:67], v2 offset:37888
    ds_read_b128 v[68:71], v2 offset:39936
    s_waitcnt vmcnt(14) lgkmcnt(4)
    v_mfma_f32_16x16x32_bf16 v[8:11], v[40:43], v[176:179], v[8:11]
    v_mfma_f32_16x16x32_bf16 v[24:27], v[40:43], v[180:183], v[24:27]
    v_mfma_f32_16x16x32_bf16 v[12:15], v[44:47], v[176:179], v[12:15]
    v_mfma_f32_16x16x32_bf16 v[28:31], v[44:47], v[180:183], v[28:31]
    v_mfma_f32_16x16x32_bf16 v[16:19], v[48:51], v[176:179], v[16:19]
    v_mfma_f32_16x16x32_bf16 v[32:35], v[48:51], v[180:183], v[32:35]
    v_mfma_f32_16x16x32_bf16 v[20:23], v[52:55], v[176:179], v[20:23]
    v_mfma_f32_16x16x32_bf16 v[36:39], v[52:55], v[180:183], v[36:39]
    buffer_load_dwordx4 v[176:179], v2, s[8:11], s35 offen offset:0 sc1
    buffer_load_dwordx4 v[180:183], v2, s[8:11], s35 offen offset:2048 sc1
    ds_read_b128 v[40:43], v2 offset:40960
    ds_read_b128 v[44:47], v2 offset:43008
    ds_read_b128 v[48:51], v2 offset:45056
    ds_read_b128 v[52:55], v2 offset:47104
    s_waitcnt vmcnt(14) lgkmcnt(4)
    v_mfma_f32_16x16x32_bf16 v[8:11], v[56:59], v[184:187], v[8:11]
    v_mfma_f32_16x16x32_bf16 v[24:27], v[56:59], v[188:191], v[24:27]
    v_mfma_f32_16x16x32_bf16 v[12:15], v[60:63], v[184:187], v[12:15]
    v_mfma_f32_16x16x32_bf16 v[28:31], v[60:63], v[188:191], v[28:31]
    v_mfma_f32_16x16x32_bf16 v[16:19], v[64:67], v[184:187], v[16:19]
    v_mfma_f32_16x16x32_bf16 v[32:35], v[64:67], v[188:191], v[32:35]
    v_mfma_f32_16x16x32_bf16 v[20:23], v[68:71], v[184:187], v[20:23]
    v_mfma_f32_16x16x32_bf16 v[36:39], v[68:71], v[188:191], v[36:39]
    buffer_load_dwordx4 v[184:187], v2, s[8:11], s35 offen offset:1024 sc1
    buffer_load_dwordx4 v[188:191], v2, s[8:11], s35 offen offset:3072 sc1
    s_add_u32 s35, s35, 16384
    ds_read_b128 v[56:59], v2 offset:41984
    ds_read_b128 v[60:63], v2 offset:44032
    ds_read_b128 v[64:67], v2 offset:46080
    ds_read_b128 v[68:71], v2 offset:48128
    s_waitcnt vmcnt(14) lgkmcnt(4)
    v_mfma_f32_16x16x32_bf16 v[8:11], v[40:43], v[192:195], v[8:11]
    v_mfma_f32_16x16x32_bf16 v[24:27], v[40:43], v[196:199], v[24:27]
    v_mfma_f32_16x16x32_bf16 v[12:15], v[44:47], v[192:195], v[12:15]
    v_mfma_f32_16x16x32_bf16 v[28:31], v[44:47], v[196:199], v[28:31]
    v_mfma_f32_16x16x32_bf16 v[16:19], v[48:51], v[192:195], v[16:19]
    v_mfma_f32_16x16x32_bf16 v[32:35], v[48:51], v[196:199], v[32:35]
    v_mfma_f32_16x16x32_bf16 v[20:23], v[52:55], v[192:195], v[20:23]
    v_mfma_f32_16x16x32_bf16 v[36:39], v[52:55], v[196:199], v[36:39]
    buffer_load_dwordx4 v[192:195], v2, s[8:11], s35 offen offset:0 sc1
    buffer_load_dwordx4 v[196:199], v2, s[8:11], s35 offen offset:2048 sc1
    ds_read_b128 v[40:43], v2 offset:49152
    ds_read_b128 v[44:47], v2 offset:51200
    ds_read_b128 v[48:51], v2 offset:53248
    ds_read_b128 v[52:55], v2 offset:55296
    s_waitcnt vmcnt(14) lgkmcnt(4)
    v_mfma_f32_16x16x32_bf16 v[8:11], v[56:59], v[200:203], v[8:11]
    v_mfma_f32_16x16x32_bf16 v[24:27], v[56:59], v[204:207], v[24:27]
    v_mfma_f32_16x16x32_bf16 v[12:15], v[60:63], v[200:203], v[12:15]
    v_mfma_f32_16x16x32_bf16 v[28:31], v[60:63], v[204:207], v[28:31]
    v_mfma_f32_16x16x32_bf16 v[16:19], v[64:67], v[200:203], v[16:19]
    v_mfma_f32_16x16x32_bf16 v[32:35], v[64:67], v[204:207], v[32:35]
    v_mfma_f32_16x16x32_bf16 v[20:23], v[68:71], v[200:203], v[20:23]
    v_mfma_f32_16x16x32_bf16 v[36:39], v[68:71], v[204:207], v[36:39]
    buffer_load_dwordx4 v[200:203], v2, s[8:11], s35 offen offset:1024 sc1
    buffer_load_dwordx4 v[204:207], v2, s[8:11], s35 offen offset:3072 sc1
    s_add_u32 s35, s35, 16384
    ds_read_b128 v[56:59], v2 offset:50176
    ds_read_b128 v[60:63], v2 offset:52224
    ds_read_b128 v[64:67], v2 offset:54272
    ds_read_b128 v[68:71], v2 offset:56320
    s_waitcnt vmcnt(14) lgkmcnt(4)
    v_mfma_f32_16x16x32_bf16 v[8:11], v[40:43], v[208:211], v[8:11]
    v_mfma_f32_16x16x32_bf16 v[24:27], v[40:43], v[212:215], v[24:27]
    v_mfma_f32_16x16x32_bf16 v[12:15], v[44:47], v[208:211], v[12:15]
    v_mfma_f32_16x16x32_bf16 v[28:31], v[44:47], v[212:215], v[28:31]
    v_mfma_f32_16x16x32_bf16 v[16:19], v[48:51], v[208:211], v[16:19]
    v_mfma_f32_16x16x32_bf16 v[32:35], v[48:51], v[212:215], v[32:35]
    v_mfma_f32_16x16x32_bf16 v[20:23], v[52:55], v[208:211], v[20:23]
    v_mfma_f32_16x16x32_bf16 v[36:39], v[52:55], v[212:215], v[36:39]
    buffer_load_dwordx4 v[208:211], v2, s[8:11], s35 offen offset:0 sc1
    buffer_load_dwordx4 v[212:215], v2, s[8:11], s35 offen offset:2048 sc1
    ds_read_b128 v[40:43], v2 offset:57344
    ds_read_b128 v[44:47], v2 offset:59392
    ds_read_b128 v[48:51], v2 offset:61440
    ds_read_b128 v[52:55], v2 offset:63488
    s_waitcnt vmcnt(14) lgkmcnt(4)
    v_mfma_f32_16x16x32_bf16 v[8:11], v[56:59], v[216:219], v[8:11]
    v_mfma_f32_16x16x32_bf16 v[24:27], v[56:59], v[220:223], v[24:27]
    v_mfma_f32_16x16x32_bf16 v[12:15], v[60:63], v[216:219], v[12:15]
    v_mfma_f32_16x16x32_bf16 v[28:31], v[60:63], v[220:223], v[28:31]
    v_mfma_f32_16x16x32_bf16 v[16:19], v[64:67], v[216:219], v[16:19]
    v_mfma_f32_16x16x32_bf16 v[32:35], v[64:67], v[220:223], v[32:35]
    v_mfma_f32_16x16x32_bf16 v[20:23], v[68:71], v[216:219], v[20:23]
    v_mfma_f32_16x16x32_bf16 v[36:39], v[68:71], v[220:223], v[36:39]
    buffer_load_dwordx4 v[216:219], v2, s[8:11], s35 offen offset:1024 sc1
    buffer_load_dwordx4 v[220:223], v2, s[8:11], s35 offen offset:3072 sc1
    s_add_u32 s35, s35, 16384
    ds_read_b128 v[56:59], v2 offset:58368
    ds_read_b128 v[60:63], v2 offset:60416
    ds_read_b128 v[64:67], v2 offset:62464
    ds_read_b128 v[68:71], v2 offset:64512
    s_waitcnt vmcnt(14) lgkmcnt(4)
    v_mfma_f32_16x16x32_bf16 v[8:11], v[40:43], v[224:227], v[8:11]
    v_mfma_f32_16x16x32_bf16 v[24:27], v[40:43], v[228:231], v[24:27]
    v_mfma_f32_16x16x32_bf16 v[12:15], v[44:47], v[224:227], v[12:15]
    v_mfma_f32_16x16x32_bf16 v[28:31], v[44:47], v[228:231], v[28:31]
    v_mfma_f32_16x16x32_bf16 v[16:19], v[48:51], v[224:227], v[16:19]
    v_mfma_f32_16x16x32_bf16 v[32:35], v[48:51], v[228:231], v[32:35]
    v_mfma_f32_16x16x32_bf16 v[20:23], v[52:55], v[224:227], v[20:23]
    v_mfma_f32_16x16x32_bf16 v[36:39], v[52:55], v[228:231], v[36:39]
    buffer_load_dwordx4 v[224:227], v2, s[8:11], s35 offen offset:0 sc1
    buffer_load_dwordx4 v[228:231], v2, s[8:11], s35 offen offset:2048 sc1
    s_barrier
    ds_read_b128 v[40:43], v3 offset:0
    ds_read_b128 v[44:47], v3 offset:2048
    ds_read_b128 v[48:51], v3 offset:4096
    ds_read_b128 v[52:55], v3 offset:6144
    s_waitcnt vmcnt(14) lgkmcnt(4)
    v_mfma_f32_16x16x32_bf16 v[8:11], v[56:59], v[232:235], v[8:11]
    v_mfma_f32_16x16x32_bf16 v[24:27], v[56:59], v[236:239], v[24:27]
    v_mfma_f32_16x16x32_bf16 v[12:15], v[60:63], v[232:235], v[12:15]
    v_mfma_f32_16x16x32_bf16 v[28:31], v[60:63], v[236:239], v[28:31]
    v_mfma_f32_16x16x32_bf16 v[16:19], v[64:67], v[232:235], v[16:19]
    v_mfma_f32_16x16x32_bf16 v[32:35], v[64:67], v[236:239], v[32:35]
    v_mfma_f32_16x16x32_bf16 v[20:23], v[68:71], v[232:235], v[20:23]
    v_mfma_f32_16x16x32_bf16 v[36:39], v[68:71], v[236:239], v[36:39]
    buffer_load_dwordx4 v[232:235], v2, s[8:11], s35 offen offset:1024 sc1
    buffer_load_dwordx4 v[236:239], v2, s[8:11], s35 offen offset:3072 sc1
    s_add_u32 s35, s35, 16384
    ds_read_b128 v[56:59], v3 offset:1024
    ds_read_b128 v[60:63], v3 offset:3072
    ds_read_b128 v[64:67], v3 offset:5120
    ds_read_b128 v[68:71], v3 offset:7168
    s_waitcnt vmcnt(14) lgkmcnt(4)
    v_mfma_f32_16x16x32_bf16 v[8:11], v[40:43], v[176:179], v[8:11]
    v_mfma_f32_16x16x32_bf16 v[24:27], v[40:43], v[180:183], v[24:27]
    v_mfma_f32_16x16x32_bf16 v[12:15], v[44:47], v[176:179], v[12:15]
    v_mfma_f32_16x16x32_bf16 v[28:31], v[44:47], v[180:183], v[28:31]
    v_mfma_f32_16x16x32_bf16 v[16:19], v[48:51], v[176:179], v[16:19]
    v_mfma_f32_16x16x32_bf16 v[32:35], v[48:51], v[180:183], v[32:35]
    v_mfma_f32_16x16x32_bf16 v[20:23], v[52:55], v[176:179], v[20:23]
    v_mfma_f32_16x16x32_bf16 v[36:39], v[52:55], v[180:183], v[36:39]
    buffer_load_dwordx4 v[176:179], v2, s[8:11], s35 offen offset:0 sc1
    buffer_load_dwordx4 v[180:183], v2, s[8:11], s35 offen offset:2048 sc1
    ds_read_b128 v[40:43], v3 offset:8192
    ds_read_b128 v[44:47], v3 offset:10240
    ds_read_b128 v[48:51], v3 offset:12288
    ds_read_b128 v[52:55], v3 offset:14336
    s_waitcnt vmcnt(14) lgkmcnt(4)
    v_mfma_f32_16x16x32_bf16 v[8:11], v[56:59], v[184:187], v[8:11]
    v_mfma_f32_16x16x32_bf16 v[24:27], v[56:59], v[188:191], v[24:27]
    v_mfma_f32_16x16x32_bf16 v[12:15], v[60:63], v[184:187], v[12:15]
    v_mfma_f32_16x16x32_bf16 v[28:31], v[60:63], v[188:191], v[28:31]
    v_mfma_f32_16x16x32_bf16 v[16:19], v[64:67], v[184:187], v[16:19]
    v_mfma_f32_16x16x32_bf16 v[32:35], v[64:67], v[188:191], v[32:35]
    v_mfma_f32_16x16x32_bf16 v[20:23], v[68:71], v[184:187], v[20:23]
    v_mfma_f32_16x16x32_bf16 v[36:39], v[68:71], v[188:191], v[36:39]
    buffer_load_dwordx4 v[184:187], v2, s[8:11], s35 offen offset:1024 sc1
    buffer_load_dwordx4 v[188:191], v2, s[8:11], s35 offen offset:3072 sc1
    s_add_u32 s35, s35, 16384
    ds_read_b128 v[56:59], v3 offset:9216
    ds_read_b128 v[60:63], v3 offset:11264
    ds_read_b128 v[64:67], v3 offset:13312
    ds_read_b128 v[68:71], v3 offset:15360
    s_waitcnt vmcnt(14) lgkmcnt(4)
    v_mfma_f32_16x16x32_bf16 v[8:11], v[40:43], v[192:195], v[8:11]
    v_mfma_f32_16x16x32_bf16 v[24:27], v[40:43], v[196:199], v[24:27]
    v_mfma_f32_16x16x32_bf16 v[12:15], v[44:47], v[192:195], v[12:15]
    v_mfma_f32_16x16x32_bf16 v[28:31], v[44:47], v[196:199], v[28:31]
    v_mfma_f32_16x16x32_bf16 v[16:19], v[48:51], v[192:195], v[16:19]
    v_mfma_f32_16x16x32_bf16 v[32:35], v[48:51], v[196:199], v[32:35]
    v_mfma_f32_16x16x32_bf16 v[20:23], v[52:55], v[192:195], v[20:23]
    v_mfma_f32_16x16x32_bf16 v[36:39], v[52:55], v[196:199], v[36:39]
    buffer_load_dwordx4 v[192:195], v2, s[8:11], s35 offen offset:0 sc1
    buffer_load_dwordx4 v[196:199], v2, s[8:11], s35 offen offset:2048 sc1
    ds_read_b128 v[40:43], v3 offset:16384
    ds_read_b128 v[44:47], v3 offset:18432
    ds_read_b128 v[48:51], v3 offset:20480
    ds_read_b128 v[52:55], v3 offset:22528
    s_waitcnt vmcnt(14) lgkmcnt(4)
    v_mfma_f32_16x16x32_bf16 v[8:11], v[56:59], v[200:203], v[8:11]
    v_mfma_f32_16x16x32_bf16 v[24:27], v[56:59], v[204:207], v[24:27]
    v_mfma_f32_16x16x32_bf16 v[12:15], v[60:63], v[200:203], v[12:15]
    v_mfma_f32_16x16x32_bf16 v[28:31], v[60:63], v[204:207], v[28:31]
    v_mfma_f32_16x16x32_bf16 v[16:19], v[64:67], v[200:203], v[16:19]
    v_mfma_f32_16x16x32_bf16 v[32:35], v[64:67], v[204:207], v[32:35]
    v_mfma_f32_16x16x32_bf16 v[20:23], v[68:71], v[200:203], v[20:23]
    v_mfma_f32_16x16x32_bf16 v[36:39], v[68:71], v[204:207], v[36:39]
    buffer_load_dwordx4 v[200:203], v2, s[8:11], s35 offen offset:1024 sc1
    buffer_load_dwordx4 v[204:207], v2, s[8:11], s35 offen offset:3072 sc1
    s_add_u32 s35, s35, 16384
    ds_read_b128 v[56:59], v3 offset:17408
    ds_read_b128 v[60:63], v3 offset:19456
    ds_read_b128 v[64:67], v3 offset:21504
    ds_read_b128 v[68:71], v3 offset:23552
    s_waitcnt vmcnt(14) lgkmcnt(4)
    v_mfma_f32_16x16x32_bf16 v[8:11], v[40:43], v[208:211], v[8:11]
    v_mfma_f32_16x16x32_bf16 v[24:27], v[40:43], v[212:215], v[24:27]
    v_mfma_f32_16x16x32_bf16 v[12:15], v[44:47], v[208:211], v[12:15]
    v_mfma_f32_16x16x32_bf16 v[28:31], v[44:47], v[212:215], v[28:31]
    v_mfma_f32_16x16x32_bf16 v[16:19], v[48:51], v[208:211], v[16:19]
    v_mfma_f32_16x16x32_bf16 v[32:35], v[48:51], v[212:215], v[32:35]
    v_mfma_f32_16x16x32_bf16 v[20:23], v[52:55], v[208:211], v[20:23]
    v_mfma_f32_16x16x32_bf16 v[36:39], v[52:55], v[212:215], v[36:39]
    buffer_load_dwordx4 v[208:211], v2, s[8:11], s35 offen offset:0 sc1
    buffer_load_dwordx4 v[212:215], v2, s[8:11], s35 offen offset:2048 sc1
    ds_read_b128 v[40:43], v3 offset:24576
    ds_read_b128 v[44:47], v3 offset:26624
    ds_read_b128 v[48:51], v3 offset:28672
    ds_read_b128 v[52:55], v3 offset:30720
    s_waitcnt vmcnt(14) lgkmcnt(4)
    v_mfma_f32_16x16x32_bf16 v[8:11], v[56:59], v[216:219], v[8:11]
    v_mfma_f32_16x16x32_bf16 v[24:27], v[56:59], v[220:223], v[24:27]
    v_mfma_f32_16x16x32_bf16 v[12:15], v[60:63], v[216:219], v[12:15]
    v_mfma_f32_16x16x32_bf16 v[28:31], v[60:63], v[220:223], v[28:31]
    v_mfma_f32_16x16x32_bf16 v[16:19], v[64:67], v[216:219], v[16:19]
    v_mfma_f32_16x16x32_bf16 v[32:35], v[64:67], v[220:223], v[32:35]
    v_mfma_f32_16x16x32_bf16 v[20:23], v[68:71], v[216:219], v[20:23]
    v_mfma_f32_16x16x32_bf16 v[36:39], v[68:71], v[220:223], v[36:39]
    buffer_load_dwordx4 v[216:219], v2, s[8:11], s35 offen offset:1024 sc1
    buffer_load_dwordx4 v[220:223], v2, s[8:11], s35 offen offset:3072 sc1
    s_add_u32 s35, s35, 16384
    ds_read_b128 v[56:59], v3 offset:25600
    ds_read_b128 v[60:63], v3 offset:27648
    ds_read_b128 v[64:67], v3 offset:29696
    ds_read_b128 v[68:71], v3 offset:31744
    s_waitcnt vmcnt(14) lgkmcnt(4)
    v_mfma_f32_16x16x32_bf16 v[8:11], v[40:43], v[224:227], v[8:11]
    v_mfma_f32_16x16x32_bf16 v[24:27], v[40:43], v[228:231], v[24:27]
    v_mfma_f32_16x16x32_bf16 v[12:15], v[44:47], v[224:227], v[12:15]
    v_mfma_f32_16x16x32_bf16 v[28:31], v[44:47], v[228:231], v[28:31]
    v_mfma_f32_16x16x32_bf16 v[16:19], v[48:51], v[224:227], v[16:19]
    v_mfma_f32_16x16x32_bf16 v[32:35], v[48:51], v[228:231], v[32:35]
    v_mfma_f32_16x16x32_bf16 v[20:23], v[52:55], v[224:227], v[20:23]
    v_mfma_f32_16x16x32_bf16 v[36:39], v[52:55], v[228:231], v[36:39]
    buffer_load_dwordx4 v[224:227], v2, s[8:11], s35 offen offset:0 sc1
    buffer_load_dwordx4 v[228:231], v2, s[8:11], s35 offen offset:2048 sc1
    ds_read_b128 v[40:43], v3 offset:32768
    ds_read_b128 v[44:47], v3 offset:34816
    ds_read_b128 v[48:51], v3 offset:36864
    ds_read_b128 v[52:55], v3 offset:38912
    s_waitcnt vmcnt(14) lgkmcnt(4)
    v_mfma_f32_16x16x32_bf16 v[8:11], v[56:59], v[232:235], v[8:11]
    v_mfma_f32_16x16x32_bf16 v[24:27], v[56:59], v[236:239], v[24:27]
    v_mfma_f32_16x16x32_bf16 v[12:15], v[60:63], v[232:235], v[12:15]
    v_mfma_f32_16x16x32_bf16 v[28:31], v[60:63], v[236:239], v[28:31]
    v_mfma_f32_16x16x32_bf16 v[16:19], v[64:67], v[232:235], v[16:19]
    v_mfma_f32_16x16x32_bf16 v[32:35], v[64:67], v[236:239], v[32:35]
    v_mfma_f32_16x16x32_bf16 v[20:23], v[68:71], v[232:235], v[20:23]
    v_mfma_f32_16x16x32_bf16 v[36:39], v[68:71], v[236:239], v[36:39]
    buffer_load_dwordx4 v[232:235], v2, s[8:11], s35 offen offset:1024 sc1
    buffer_load_dwordx4 v[236:239], v2, s[8:11], s35 offen offset:3072 sc1
    s_add_u32 s35, s35, 16384
    ds_read_b128 v[56:59], v3 offset:33792
    ds_read_b128 v[60:63], v3 offset:35840
    ds_read_b128 v[64:67], v3 offset:37888
    ds_read_b128 v[68:71], v3 offset:39936
    s_waitcnt vmcnt(14) lgkmcnt(4)
    v_mfma_f32_16x16x32_bf16 v[8:11], v[40:43], v[176:179], v[8:11]
    v_mfma_f32_16x16x32_bf16 v[24:27], v[40:43], v[180:183], v[24:27]
    v_mfma_f32_16x16x32_bf16 v[12:15], v[44:47], v[176:179], v[12:15]
    v_mfma_f32_16x16x32_bf16 v[28:31], v[44:47], v[180:183], v[28:31]
    v_mfma_f32_16x16x32_bf16 v[16:19], v[48:51], v[176:179], v[16:19]
    v_mfma_f32_16x16x32_bf16 v[32:35], v[48:51], v[180:183], v[32:35]
    v_mfma_f32_16x16x32_bf16 v[20:23], v[52:55], v[176:179], v[20:23]
    v_mfma_f32_16x16x32_bf16 v[36:39], v[52:55], v[180:183], v[36:39]
    ds_read_b128 v[40:43], v3 offset:40960
    ds_read_b128 v[44:47], v3 offset:43008
    ds_read_b128 v[48:51], v3 offset:45056
    ds_read_b128 v[52:55], v3 offset:47104
    s_waitcnt vmcnt(12) lgkmcnt(4)
    v_mfma_f32_16x16x32_bf16 v[8:11], v[56:59], v[184:187], v[8:11]
    v_mfma_f32_16x16x32_bf16 v[24:27], v[56:59], v[188:191], v[24:27]
    v_mfma_f32_16x16x32_bf16 v[12:15], v[60:63], v[184:187], v[12:15]
    v_mfma_f32_16x16x32_bf16 v[28:31], v[60:63], v[188:191], v[28:31]
    v_mfma_f32_16x16x32_bf16 v[16:19], v[64:67], v[184:187], v[16:19]
    v_mfma_f32_16x16x32_bf16 v[32:35], v[64:67], v[188:191], v[32:35]
    v_mfma_f32_16x16x32_bf16 v[20:23], v[68:71], v[184:187], v[20:23]
    v_mfma_f32_16x16x32_bf16 v[36:39], v[68:71], v[188:191], v[36:39]
    ds_read_b128 v[56:59], v3 offset:41984
    ds_read_b128 v[60:63], v3 offset:44032
    ds_read_b128 v[64:67], v3 offset:46080
    ds_read_b128 v[68:71], v3 offset:48128
    s_waitcnt vmcnt(10) lgkmcnt(4)
    v_mfma_f32_16x16x32_bf16 v[8:11], v[40:43], v[192:195], v[8:11]
    v_mfma_f32_16x16x32_bf16 v[24:27], v[40:43], v[196:199], v[24:27]
    v_mfma_f32_16x16x32_bf16 v[12:15], v[44:47], v[192:195], v[12:15]
    v_mfma_f32_16x16x32_bf16 v[28:31], v[44:47], v[196:199], v[28:31]
    v_mfma_f32_16x16x32_bf16 v[16:19], v[48:51], v[192:195], v[16:19]
    v_mfma_f32_16x16x32_bf16 v[32:35], v[48:51], v[196:199], v[32:35]
    v_mfma_f32_16x16x32_bf16 v[20:23], v[52:55], v[192:195], v[20:23]
    v_mfma_f32_16x16x32_bf16 v[36:39], v[52:55], v[196:199], v[36:39]
    ds_read_b128 v[40:43], v3 offset:49152
    ds_read_b128 v[44:47], v3 offset:51200
    ds_read_b128 v[48:51], v3 offset:53248
    ds_read_b128 v[52:55], v3 offset:55296
    s_waitcnt vmcnt(8) lgkmcnt(4)
    v_mfma_f32_16x16x32_bf16 v[8:11], v[56:59], v[200:203], v[8:11]
    v_mfma_f32_16x16x32_bf16 v[24:27], v[56:59], v[204:207], v[24:27]
    v_mfma_f32_16x16x32_bf16 v[12:15], v[60:63], v[200:203], v[12:15]
    v_mfma_f32_16x16x32_bf16 v[28:31], v[60:63], v[204:207], v[28:31]
    v_mfma_f32_16x16x32_bf16 v[16:19], v[64:67], v[200:203], v[16:19]
    v_mfma_f32_16x16x32_bf16 v[32:35], v[64:67], v[204:207], v[32:35]
    v_mfma_f32_16x16x32_bf16 v[20:23], v[68:71], v[200:203], v[20:23]
    v_mfma_f32_16x16x32_bf16 v[36:39], v[68:71], v[204:207], v[36:39]
    ds_read_b128 v[56:59], v3 offset:50176
    ds_read_b128 v[60:63], v3 offset:52224
    ds_read_b128 v[64:67], v3 offset:54272
    ds_read_b128 v[68:71], v3 offset:56320
    s_waitcnt vmcnt(6) lgkmcnt(4)
    v_mfma_f32_16x16x32_bf16 v[8:11], v[40:43], v[208:211], v[8:11]
    v_mfma_f32_16x16x32_bf16 v[24:27], v[40:43], v[212:215], v[24:27]
    v_mfma_f32_16x16x32_bf16 v[12:15], v[44:47], v[208:211], v[12:15]
    v_mfma_f32_16x16x32_bf16 v[28:31], v[44:47], v[212:215], v[28:31]
    v_mfma_f32_16x16x32_bf16 v[16:19], v[48:51], v[208:211], v[16:19]
    v_mfma_f32_16x16x32_bf16 v[32:35], v[48:51], v[212:215], v[32:35]
    v_mfma_f32_16x16x32_bf16 v[20:23], v[52:55], v[208:211], v[20:23]
    v_mfma_f32_16x16x32_bf16 v[36:39], v[52:55], v[212:215], v[36:39]
    ds_read_b128 v[40:43], v3 offset:57344
    ds_read_b128 v[44:47], v3 offset:59392
    ds_read_b128 v[48:51], v3 offset:61440
    ds_read_b128 v[52:55], v3 offset:63488
    s_waitcnt vmcnt(4) lgkmcnt(4)
    v_mfma_f32_16x16x32_bf16 v[8:11], v[56:59], v[216:219], v[8:11]
    v_mfma_f32_16x16x32_bf16 v[24:27], v[56:59], v[220:223], v[24:27]
    v_mfma_f32_16x16x32_bf16 v[12:15], v[60:63], v[216:219], v[12:15]
    v_mfma_f32_16x16x32_bf16 v[28:31], v[60:63], v[220:223], v[28:31]
    v_mfma_f32_16x16x32_bf16 v[16:19], v[64:67], v[216:219], v[16:19]
    v_mfma_f32_16x16x32_bf16 v[32:35], v[64:67], v[220:223], v[32:35]
    v_mfma_f32_16x16x32_bf16 v[20:23], v[68:71], v[216:219], v[20:23]
    v_mfma_f32_16x16x32_bf16 v[36:39], v[68:71], v[220:223], v[36:39]
    ds_read_b128 v[56:59], v3 offset:58368
    ds_read_b128 v[60:63], v3 offset:60416
    ds_read_b128 v[64:67], v3 offset:62464
    ds_read_b128 v[68:71], v3 offset:64512
    s_waitcnt vmcnt(2) lgkmcnt(4)
    v_mfma_f32_16x16x32_bf16 v[8:11], v[40:43], v[224:227], v[8:11]
    v_mfma_f32_16x16x32_bf16 v[24:27], v[40:43], v[228:231], v[24:27]
    v_mfma_f32_16x16x32_bf16 v[12:15], v[44:47], v[224:227], v[12:15]
    v_mfma_f32_16x16x32_bf16 v[28:31], v[44:47], v[228:231], v[28:31]
    v_mfma_f32_16x16x32_bf16 v[16:19], v[48:51], v[224:227], v[16:19]
    v_mfma_f32_16x16x32_bf16 v[32:35], v[48:51], v[228:231], v[32:35]
    v_mfma_f32_16x16x32_bf16 v[20:23], v[52:55], v[224:227], v[20:23]
    v_mfma_f32_16x16x32_bf16 v[36:39], v[52:55], v[228:231], v[36:39]
    s_waitcnt vmcnt(0) lgkmcnt(0)
    s_barrier
    v_mfma_f32_16x16x32_bf16 v[8:11], v[56:59], v[232:235], v[8:11]
    v_mfma_f32_16x16x32_bf16 v[24:27], v[56:59], v[236:239], v[24:27]
    v_mfma_f32_16x16x32_bf16 v[12:15], v[60:63], v[232:235], v[12:15]
    v_mfma_f32_16x16x32_bf16 v[28:31], v[60:63], v[236:239], v[28:31]
    v_mfma_f32_16x16x32_bf16 v[16:19], v[64:67], v[232:235], v[16:19]
    v_mfma_f32_16x16x32_bf16 v[32:35], v[64:67], v[236:239], v[32:35]
    v_mfma_f32_16x16x32_bf16 v[20:23], v[68:71], v[232:235], v[20:23]
    v_mfma_f32_16x16x32_bf16 v[36:39], v[68:71], v[236:239], v[36:39]
    s_nop 7
    s_add_u32 s16, s4, 0x1400000
    s_addc_u32 s17, s5, 0
    s_mov_b32 s18, 0x400000
    s_mov_b32 s19, 0x20000
    s_add_u32 s24, s4, 0x2600000
    s_addc_u32 s25, s5, 0
    s_mov_b32 s26, 0x40000
    s_mov_b32 s27, 0x20000
    s_lshl_b32 s41, s31, 18
    s_lshl_b32 s3, s32, 14
    s_add_u32 s41, s41, s3
    s_lshl_b32 s3, s39, 12
    s_add_u32 s41, s41, s3
    s_waitcnt vmcnt(0)
    v_lshlrev_b32 v120, 16, v100
    v_and_b32 v121, 0xffff0000, v100
    v_lshlrev_b32 v122, 16, v101
    v_and_b32 v123, 0xffff0000, v101
    v_lshlrev_b32 v124, 16, v102
    v_and_b32 v125, 0xffff0000, v102
    v_lshlrev_b32 v126, 16, v103
    v_and_b32 v127, 0xffff0000, v103
    v_lshlrev_b32 v128, 16, v104
    v_and_b32 v129, 0xffff0000, v104
    v_lshlrev_b32 v130, 16, v105
    v_and_b32 v131, 0xffff0000, v105
    v_lshlrev_b32 v132, 16, v106
    v_and_b32 v133, 0xffff0000, v106
    v_lshlrev_b32 v134, 16, v107
    v_and_b32 v135, 0xffff0000, v107
    v_lshlrev_b32 v136, 16, v108
    v_and_b32 v137, 0xffff0000, v108
    v_lshlrev_b32 v138, 16, v109
    v_and_b32 v139, 0xffff0000, v109
    v_lshlrev_b32 v140, 16, v110
    v_and_b32 v141, 0xffff0000, v110
    v_lshlrev_b32 v142, 16, v111
    v_and_b32 v143, 0xffff0000, v111
    v_lshlrev_b32 v144, 16, v112
    v_and_b32 v145, 0xffff0000, v112
    v_lshlrev_b32 v146, 16, v113
    v_and_b32 v147, 0xffff0000, v113
    v_lshlrev_b32 v148, 16, v114
    v_and_b32 v149, 0xffff0000, v114
    v_lshlrev_b32 v150, 16, v115
    v_and_b32 v151, 0xffff0000, v115
    v_pk_add_f32 v[8:9], v[8:9], v[120:121]
    v_pk_add_f32 v[10:11], v[10:11], v[122:123]
    v_pk_add_f32 v[12:13], v[12:13], v[124:125]
    v_pk_add_f32 v[14:15], v[14:15], v[126:127]
    v_pk_add_f32 v[16:17], v[16:17], v[128:129]
    v_pk_add_f32 v[18:19], v[18:19], v[130:131]
    v_pk_add_f32 v[20:21], v[20:21], v[132:133]
    v_pk_add_f32 v[22:23], v[22:23], v[134:135]
    v_pk_add_f32 v[24:25], v[24:25], v[136:137]
    v_pk_add_f32 v[26:27], v[26:27], v[138:139]
    v_pk_add_f32 v[28:29], v[28:29], v[140:141]
    v_pk_add_f32 v[30:31], v[30:31], v[142:143]
    v_pk_add_f32 v[32:33], v[32:33], v[144:145]
    v_pk_add_f32 v[34:35], v[34:35], v[146:147]
    v_pk_add_f32 v[36:37], v[36:37], v[148:149]
    v_pk_add_f32 v[38:39], v[38:39], v[150:151]
    v_cvt_pk_bf16_f32 v40, v8, v9
    v_cvt_pk_bf16_f32 v41, v10, v11
    v_cvt_pk_bf16_f32 v42, v12, v13
    v_cvt_pk_bf16_f32 v43, v14, v15
    v_cvt_pk_bf16_f32 v44, v16, v17
    v_cvt_pk_bf16_f32 v45, v18, v19
    v_cvt_pk_bf16_f32 v46, v20, v21
    v_cvt_pk_bf16_f32 v47, v22, v23
    v_cvt_pk_bf16_f32 v48, v24, v25
    v_cvt_pk_bf16_f32 v49, v26, v27
    v_cvt_pk_bf16_f32 v50, v28, v29
    v_cvt_pk_bf16_f32 v51, v30, v31
    v_cvt_pk_bf16_f32 v52, v32, v33
    v_cvt_pk_bf16_f32 v53, v34, v35
    v_cvt_pk_bf16_f32 v54, v36, v37
    v_cvt_pk_bf16_f32 v55, v38, v39
    buffer_store_dwordx4 v[40:43], v2, s[16:19], s41 offen offset:0 sc1
    buffer_store_dwordx4 v[44:47], v2, s[16:19], s41 offen offset:1024 sc1
    buffer_store_dwordx4 v[48:51], v2, s[16:19], s41 offen offset:2048 sc1
    buffer_store_dwordx4 v[52:55], v2, s[16:19], s41 offen offset:3072 sc1
    v_pk_add_f32 v[100:101], v[8:9], v[10:11]
    v_pk_mul_f32 v[102:103], v[8:9], v[8:9]
    v_pk_fma_f32 v[102:103], v[10:11], v[10:11], v[102:103]
    v_pk_add_f32 v[100:101], v[100:101], v[12:13]
    v_pk_fma_f32 v[102:103], v[12:13], v[12:13], v[102:103]
    v_pk_add_f32 v[100:101], v[100:101], v[14:15]
    v_pk_fma_f32 v[102:103], v[14:15], v[14:15], v[102:103]
    v_pk_add_f32 v[100:101], v[100:101], v[16:17]
    v_pk_fma_f32 v[102:103], v[16:17], v[16:17], v[102:103]
    v_pk_add_f32 v[100:101], v[100:101], v[18:19]
    v_pk_fma_f32 v[102:103], v[18:19], v[18:19], v[102:103]
    v_pk_add_f32 v[100:101], v[100:101], v[20:21]
    v_pk_fma_f32 v[102:103], v[20:21], v[20:21], v[102:103]
    v_pk_add_f32 v[100:101], v[100:101], v[22:23]
    v_pk_fma_f32 v[102:103], v[22:23], v[22:23], v[102:103]
    v_add_f32 v100, v100, v101
    v_add_f32 v102, v102, v103
    v_pk_add_f32 v[104:105], v[24:25], v[26:27]
    v_pk_mul_f32 v[106:107], v[24:25], v[24:25]
    v_pk_fma_f32 v[106:107], v[26:27], v[26:27], v[106:107]
    v_pk_add_f32 v[104:105], v[104:105], v[28:29]
    v_pk_fma_f32 v[106:107], v[28:29], v[28:29], v[106:107]
    v_pk_add_f32 v[104:105], v[104:105], v[30:31]
    v_pk_fma_f32 v[106:107], v[30:31], v[30:31], v[106:107]
    v_pk_add_f32 v[104:105], v[104:105], v[32:33]
    v_pk_fma_f32 v[106:107], v[32:33], v[32:33], v[106:107]
    v_pk_add_f32 v[104:105], v[104:105], v[34:35]
    v_pk_fma_f32 v[106:107], v[34:35], v[34:35], v[106:107]
    v_pk_add_f32 v[104:105], v[104:105], v[36:37]
    v_pk_fma_f32 v[106:107], v[36:37], v[36:37], v[106:107]
    v_pk_add_f32 v[104:105], v[104:105], v[38:39]
    v_pk_fma_f32 v[106:107], v[38:39], v[38:39], v[106:107]
    v_add_f32 v104, v104, v105
    v_add_f32 v106, v106, v107
    s_lshl_b32 s42, s31, 2
    s_add_u32 s42, s42, s39
    s_lshl_b32 s42, s42, 12
    s_lshl_b32 s3, s32, 8
    s_add_u32 s42, s42, s3
    v_permlane32_swap_b32 v100, v104
    v_permlane32_swap_b32 v102, v106
    v_and_b32 v3, 15, v0
    v_lshlrev_b32 v3, 3, v3
    v_add_f32 v100, v100, v104
    v_add_f32 v102, v102, v106
    v_lshrrev_b32 v4, 5, v0
    v_lshl_add_u32 v3, v4, 7, v3
    v_permlane16_swap_b32 v100, v102
    v_bfe_u32 v4, v0, 4, 1
    v_lshl_add_u32 v3, v4, 2, v3
    v_add_f32 v100, v100, v102
    buffer_store_dword v100, v3, s[24:27], s42 offen sc1
    s_lshl_b32 s43, s31, 2
    s_add_u32 s43, s43, s39
    s_lshl_b32 s43, s43, 4
    s_add_u32 s43, s43, s32
    s_lshl_b32 s43, s43, 7
    s_add_u32 s43, s43, 393216
    v_lshlrev_b32 v240, 7, v0
    v_mov_b32 v241, 1
    s_waitcnt vmcnt(0)
    s_mov_b64 exec, 1
    buffer_store_dword v241, v240, s[88:91], s43 offen sc1
    s_mov_b64 exec, -1
oproj_end:
    s_mov_b32 s30, s29
    s_load_dwordx2 s[48:49], s[0:1], 40
    s_and_b32 s37, s2, 7
    s_lshr_b32 s38, s2, 3
    s_and_b32 s31, s37, 1
    s_lshl_b32 s31, s31, 3
    s_and_b32 s3, s38, 7
    s_add_u32 s31, s31, s3
    s_lshr_b32 s32, s37, 1
    s_lshl_b32 s32, s32, 2
    s_lshr_b32 s3, s38, 3
    s_add_u32 s32, s32, s3
    v_lshlrev_b32 v2, 4, v0
    s_cmp_lt_u32 s30, 4
    s_cbranch_scc1 ffn1_cons
    s_sub_u32 s30, s30, 4
    s_lshl_b32 s41, s30, 12
    s_mul_i32 s42, s30, 7168
    s_mul_i32 s35, s31, 262144
    s_add_u32 s35, s35, s41
    s_mul_i32 s36, s32, 458752
    s_add_u32 s36, s36, s42
    s_add_u32 s42, s42, 16384
    s_mov_b32 s33, 0
    s_waitcnt lgkmcnt(0)
    s_add_u32 s8, s4, 0x1400000
    s_addc_u32 s9, s5, 0
    s_mov_b32 s10, 0x400000
    s_mov_b32 s11, 0x20000
    s_add_u32 s12, s4, 0x3400000
    s_addc_u32 s13, s5, 0
    s_mov_b32 s14, 0x700000
    s_mov_b32 s15, 0x20000
    s_add_u32 s88, s4, 0x4400000
    s_addc_u32 s89, s5, 0
    s_mov_b32 s90, 0xe1400
    s_mov_b32 s91, 0x20000
    s_mov_b32 s43, 655360
    v_min_u32 v244, 55, v0
    v_lshlrev_b32 v244, 4, v244
    s_mov_b32 s87, 0x40000
    s_mov_b32 s86, 0x1
ffn1_plw:
    buffer_load_dwordx4 v[240:243], v244, s[88:91], s43 offen sc1
    s_waitcnt vmcnt(0)
    v_and_b32 v240, v240, v241
    v_and_b32 v242, v242, v243
    v_and_b32 v240, v240, v242
    v_cmp_ne_u32 vcc, s86, v240
    s_sub_u32 s87, s87, 1
    s_nop 3
    s_cbranch_vccz ffn1_pdw
    s_sleep 6
    s_cmp_lg_u32 s87, 0
    s_cbranch_scc1 ffn1_plw
ffn1_pdw:
    s_mov_b32 s34, 2
ffn1_lpw:
    s_add_u32 m0, s33, s42
    s_add_u32 s38, s36, 4096
    buffer_load_dwordx4 v2, s[12:15], s36 offen offset:0 sc1 lds
    buffer_load_dwordx4 v2, s[12:15], s36 offen offset:1024 sc1 lds
    buffer_load_dwordx4 v2, s[12:15], s36 offen offset:2048 sc1 lds
    buffer_load_dwordx4 v2, s[12:15], s36 offen offset:3072 sc1 lds
    s_add_u32 m0, m0, 4096
    s_nop 0
    buffer_load_dwordx4 v2, s[12:15], s38 offen offset:0 sc1 lds
    buffer_load_dwordx4 v2, s[12:15], s38 offen offset:1024 sc1 lds
    buffer_load_dwordx4 v2, s[12:15], s38 offen offset:2048 sc1 lds
    s_add_u32 s36, s36, 28672
    s_add_u32 s33, s33, 45056
    s_cmp_ge_u32 s33, 135168
    s_cselect_b32 s33, 0, s33
    s_sub_u32 s34, s34, 1
    s_cmp_lg_u32 s34, 0
    s_cbranch_scc1 ffn1_lpw
    s_lshl_b32 s43, s31, 2
    s_add_u32 s43, s43, s30
    s_lshr_b32 s43, s43, 0
    s_mul_i32 s43, s43, 2048
    s_add_u32 s43, s43, 393216
    s_mov_b32 s33, 0
    s_barrier
    v_min_u32 v244, 15, v0
    v_lshlrev_b32 v244, 7, v244
    s_mov_b32 s87, 0x40000
    s_mov_b32 s86, 0x1
ffn1_plx:
    buffer_load_dword v240, v244, s[88:91], s43 offen sc1
    s_waitcnt vmcnt(0)
    v_cmp_ne_u32 vcc, s86, v240
    s_sub_u32 s87, s87, 1
    s_nop 3
    s_cbranch_vccz ffn1_pdx
    s_sleep 6
    s_cmp_lg_u32 s87, 0
    s_cbranch_scc1 ffn1_plx
ffn1_pdx:
    s_mov_b32 s34, 2
ffn1_lpx:
    s_add_u32 m0, s33, s41
    s_nop 0
    buffer_load_dwordx4 v2, s[8:11], s35 offen offset:0 sc1 lds
    buffer_load_dwordx4 v2, s[8:11], s35 offen offset:1024 sc1 lds
    buffer_load_dwordx4 v2, s[8:11], s35 offen offset:2048 sc1 lds
    buffer_load_dwordx4 v2, s[8:11], s35 offen offset:3072 sc1 lds
    s_add_u32 s35, s35, 16384
    s_add_u32 s33, s33, 45056
    s_cmp_ge_u32 s33, 135168
    s_cselect_b32 s33, 0, s33
    s_sub_u32 s34, s34, 1
    s_cmp_lg_u32 s34, 0
    s_cbranch_scc1 ffn1_lpx
    s_waitcnt vmcnt(4)
    s_barrier
    s_add_u32 m0, s33, s42
    s_add_u32 s38, s36, 4096
    buffer_load_dwordx4 v2, s[12:15], s36 offen offset:0 sc1 lds
    buffer_load_dwordx4 v2, s[12:15], s36 offen offset:1024 sc1 lds
    buffer_load_dwordx4 v2, s[12:15], s36 offen offset:2048 sc1 lds
    buffer_load_dwordx4 v2, s[12:15], s36 offen offset:3072 sc1 lds
    s_add_u32 m0, m0, 4096
    s_nop 0
    buffer_load_dwordx4 v2, s[12:15], s38 offen offset:0 sc1 lds
    buffer_load_dwordx4 v2, s[12:15], s38 offen offset:1024 sc1 lds
    buffer_load_dwordx4 v2, s[12:15], s38 offen offset:2048 sc1 lds
    s_add_u32 s36, s36, 28672
    s_add_u32 m0, s33, s41
    s_nop 0
    buffer_load_dwordx4 v2, s[8:11], s35 offen offset:0 sc1 lds
    buffer_load_dwordx4 v2, s[8:11], s35 offen offset:1024 sc1 lds
    buffer_load_dwordx4 v2, s[8:11], s35 offen offset:2048 sc1 lds
    buffer_load_dwordx4 v2, s[8:11], s35 offen offset:3072 sc1 lds
    s_add_u32 s35, s35, 16384
    s_add_u32 s33, s33, 45056
    s_cmp_ge_u32 s33, 135168
    s_cselect_b32 s33, 0, s33
    s_waitcnt vmcnt(11)
    s_barrier
    s_add_u32 m0, s33, s42
    s_add_u32 s38, s36, 4096
    buffer_load_dwordx4 v2, s[12:15], s36 offen offset:0 sc1 lds
    buffer_load_dwordx4 v2, s[12:15], s36 offen offset:1024 sc1 lds
    buffer_load_dwordx4 v2, s[12:15], s36 offen offset:2048 sc1 lds
    buffer_load_dwordx4 v2, s[12:15], s36 offen offset:3072 sc1 lds
    s_add_u32 m0, m0, 4096
    s_nop 0
    buffer_load_dwordx4 v2, s[12:15], s38 offen offset:0 sc1 lds
    buffer_load_dwordx4 v2, s[12:15], s38 offen offset:1024 sc1 lds
    buffer_load_dwordx4 v2, s[12:15], s38 offen offset:2048 sc1 lds
    s_add_u32 s36, s36, 28672
    s_add_u32 m0, s33, s41
    s_nop 0
    buffer_load_dwordx4 v2, s[8:11], s35 offen offset:0 sc1 lds
    buffer_load_dwordx4 v2, s[8:11], s35 offen offset:1024 sc1 lds
    buffer_load_dwordx4 v2, s[8:11], s35 offen offset:2048 sc1 lds
    buffer_load_dwordx4 v2, s[8:11], s35 offen offset:3072 sc1 lds
    s_add_u32 s35, s35, 16384
    s_add_u32 s33, s33, 45056
    s_cmp_ge_u32 s33, 135168
    s_cselect_b32 s33, 0, s33
    s_mov_b32 s34, 12
ffn1_lloop:
    s_waitcnt vmcnt(11)
    s_barrier
    s_add_u32 m0, s33, s42
    s_add_u32 s38, s36, 4096
    buffer_load_dwordx4 v2, s[12:15], s36 offen offset:0 sc1 lds
    buffer_load_dwordx4 v2, s[12:15], s36 offen offset:1024 sc1 lds
    buffer_load_dwordx4 v2, s[12:15], s36 offen offset:2048 sc1 lds
    buffer_load_dwordx4 v2, s[12:15], s36 offen offset:3072 sc1 lds
    s_add_u32 m0, m0, 4096
    s_nop 0
    buffer_load_dwordx4 v2, s[12:15], s38 offen offset:0 sc1 lds
    buffer_load_dwordx4 v2, s[12:15], s38 offen offset:1024 sc1 lds
    buffer_load_dwordx4 v2, s[12:15], s38 offen offset:2048 sc1 lds
    s_add_u32 s36, s36, 28672
    s_add_u32 m0, s33, s41
    s_nop 0
    buffer_load_dwordx4 v2, s[8:11], s35 offen offset:0 sc1 lds
    buffer_load_dwordx4 v2, s[8:11], s35 offen offset:1024 sc1 lds
    buffer_load_dwordx4 v2, s[8:11], s35 offen offset:2048 sc1 lds
    buffer_load_dwordx4 v2, s[8:11], s35 offen offset:3072 sc1 lds
    s_add_u32 s35, s35, 16384
    s_add_u32 s33, s33, 45056
    s_cmp_ge_u32 s33, 135168
    s_cselect_b32 s33, 0, s33
    s_sub_u32 s34, s34, 1
    s_cmp_lg_u32 s34, 0
    s_cbranch_scc1 ffn1_lloop
    s_add_u32 s20, s4, 0x2700000
    s_addc_u32 s21, s5, 0
    s_mov_b32 s22, 0xe000
    s_mov_b32 s23, 0x20000
    s_mov_b32 s24, s48
    s_mov_b32 s25, s49
    s_mov_b32 s26, 0x1c00
    s_mov_b32 s27, 0x20000
    s_lshl_b32 s37, s30, 6
    v_add_u32 v20, s37, v0
    s_mul_i32 s37, s32, 224
    v_add_u32 v21, s37, v20
    v_lshlrev_b32 v22, 2, v21
    v_lshlrev_b32 v21, 1, v21
    buffer_load_ushort v40, v21, s[24:27], 0 offen
    s_mov_b32 s37, 0
    buffer_load_dword v24, v22, s[20:23], s37 offen sc1
    s_mov_b32 s37, 14336
    buffer_load_dword v25, v22, s[20:23], s37 offen sc1
    s_mov_b32 s37, 28672
    buffer_load_dword v26, v22, s[20:23], s37 offen sc1
    s_mov_b32 s37, 43008
    buffer_load_dword v27, v22, s[20:23], s37 offen sc1
    s_add_u32 s24, s4, 0x2600000
    s_addc_u32 s25, s5, 0
    s_mov_b32 s26, 0x40000
    s_mov_b32 s27, 0x20000
    v_and_b32 v41, 127, v20
    v_lshrrev_b32 v42, 5, v41
    v_and_b32 v43, 31, v41
    v_lshlrev_b32 v43, 3, v43
    v_lshl_add_u32 v42, v42, 12, v43
    s_lshl_b32 s37, s31, 14
    buffer_load_dwordx2 v[44:45], v42, s[24:27], s37 offen offset:0 sc1
    buffer_load_dwordx2 v[46:47], v42, s[24:27], s37 offen offset:256 sc1
    buffer_load_dwordx2 v[48:49], v42, s[24:27], s37 offen offset:512 sc1
    buffer_load_dwordx2 v[50:51], v42, s[24:27], s37 offen offset:768 sc1
    buffer_load_dwordx2 v[52:53], v42, s[24:27], s37 offen offset:1024 sc1
    buffer_load_dwordx2 v[54:55], v42, s[24:27], s37 offen offset:1280 sc1
    buffer_load_dwordx2 v[56:57], v42, s[24:27], s37 offen offset:1536 sc1
    buffer_load_dwordx2 v[58:59], v42, s[24:27], s37 offen offset:1792 sc1
    buffer_load_dwordx2 v[60:61], v42, s[24:27], s37 offen offset:2048 sc1
    buffer_load_dwordx2 v[62:63], v42, s[24:27], s37 offen offset:2304 sc1
    buffer_load_dwordx2 v[64:65], v42, s[24:27], s37 offen offset:2560 sc1
    buffer_load_dwordx2 v[66:67], v42, s[24:27], s37 offen offset:2816 sc1
    buffer_load_dwordx2 v[68:69], v42, s[24:27], s37 offen offset:3072 sc1
    buffer_load_dwordx2 v[70:71], v42, s[24:27], s37 offen offset:3328 sc1
    buffer_load_dwordx2 v[72:73], v42, s[24:27], s37 offen offset:3584 sc1
    buffer_load_dwordx2 v[74:75], v42, s[24:27], s37 offen offset:3840 sc1
    s_waitcnt vmcnt(32)
    s_barrier
    s_waitcnt vmcnt(21)
    s_barrier
    s_waitcnt vmcnt(0)
    v_add_f32 v24, v24, v25
    v_add_f32 v24, v24, v26
    v_add_f32 v24, v24, v27
    v_pk_add_f32 v[44:45], v[44:45], v[46:47]
    v_pk_add_f32 v[44:45], v[44:45], v[48:49]
    v_pk_add_f32 v[44:45], v[44:45], v[50:51]
    v_pk_add_f32 v[44:45], v[44:45], v[52:53]
    v_pk_add_f32 v[44:45], v[44:45], v[54:55]
    v_pk_add_f32 v[44:45], v[44:45], v[56:57]
    v_pk_add_f32 v[44:45], v[44:45], v[58:59]
    v_pk_add_f32 v[44:45], v[44:45], v[60:61]
    v_pk_add_f32 v[44:45], v[44:45], v[62:63]
    v_pk_add_f32 v[44:45], v[44:45], v[64:65]
    v_pk_add_f32 v[44:45], v[44:45], v[66:67]
    v_pk_add_f32 v[44:45], v[44:45], v[68:69]
    v_pk_add_f32 v[44:45], v[44:45], v[70:71]
    v_pk_add_f32 v[44:45], v[44:45], v[72:73]
    v_pk_add_f32 v[44:45], v[44:45], v[74:75]
    v_mul_f32 v44, 0xba800000, v44
    v_mul_f32 v45, 0x3a800000, v45
    v_fma_f32 v45, -v44, v44, v45
    v_max_f32 v45, 0, v45
    v_add_f32 v45, 0x3727c5ac, v45
    v_rsq_f32 v46, v45
    v_lshlrev_b32 v41, 2, v41
    v_add_u32 v41, 149504, v41
    ds_write_b32 v41, v44
    ds_write_b32 v41, v46 offset:512
    v_lshlrev_b32 v40, 16, v40
    v_lshrrev_b32 v21, 5, v20
    v_bfe_u32 v22, v20, 2, 1
    v_lshl_add_u32 v25, v21, 1, v22
    v_bfe_u32 v28, v20, 3, 2
    v_bfe_u32 v29, v20, 2, 2
    v_bfe_u32 v22, v20, 4, 1
    v_cmp_lt_u32 vcc, 3, v21
    v_subrev_u32 v26, 1, v25
    v_mul_u32_u24 v27, 7, v22
    v_cndmask_b32 v25, v25, v26, vcc
    v_cmp_eq_u32 vcc, 3, v21
    v_add_u32 v27, 6, v27
    s_nop 0
    v_cndmask_b32 v25, v25, v27, vcc
    v_cndmask_b32 v28, v28, v29, vcc
    v_cmp_eq_u32 vcc, 7, v21
    v_mov_b32 v27, 15
    s_nop 0
    v_cndmask_b32 v25, v25, v27, vcc
    v_lshlrev_b32 v25, 6, v25
    v_lshl_add_u32 v25, v28, 4, v25
    v_and_b32 v26, 3, v20
    v_lshl_add_u32 v25, v26, 2, v25
    v_add_u32 v25, 147456, v25
    ds_write_b32 v25, v24
    ds_write_b32 v25, v40 offset:1024
    s_waitcnt lgkmcnt(0)
    s_barrier
    s_branch ffn1_end
ffn1_cons:
    s_lshr_b32 s39, s30, 1
    s_and_b32 s40, s30, 1
    s_mul_i32 s37, s39, 8192
    v_add_u32 v4, s37, v2
    s_mul_i32 s37, s40, 14336
    s_add_u32 s37, s37, 16384
    v_add_u32 v5, s37, v2
    v_mov_b32 v6, v4
    v_mov_b32 v3, v5
    s_mov_b32 s33, 0
    s_mov_b32 s34, 16
    s_waitcnt lgkmcnt(0)
    s_barrier
    v_mov_b32 v8, 0
    v_mov_b32 v9, 0
    v_mov_b32 v10, 0
    v_mov_b32 v11, 0
    v_mov_b32 v12, 0
    v_mov_b32 v13, 0
    v_mov_b32 v14, 0
    v_mov_b32 v15, 0
    v_mov_b32 v16, 0
    v_mov_b32 v17, 0
    v_mov_b32 v18, 0
    v_mov_b32 v19, 0
    v_mov_b32 v20, 0
    v_mov_b32 v21, 0
    v_mov_b32 v22, 0
    v_mov_b32 v23, 0
    v_mov_b32 v24, 0
    v_mov_b32 v25, 0
    v_mov_b32 v26, 0
    v_mov_b32 v27, 0
    v_mov_b32 v28, 0
    v_mov_b32 v29, 0
    v_mov_b32 v30, 0
    v_mov_b32 v31, 0
    v_mov_b32 v32, 0
    v_mov_b32 v33, 0
    v_mov_b32 v34, 0
    v_mov_b32 v35, 0
    v_mov_b32 v36, 0
    v_mov_b32 v37, 0
    v_mov_b32 v38, 0
    v_mov_b32 v39, 0
    v_mov_b32 v40, 0
    v_mov_b32 v41, 0
    v_mov_b32 v42, 0
    v_mov_b32 v43, 0
    v_mov_b32 v44, 0
    v_mov_b32 v45, 0
    v_mov_b32 v46, 0
    v_mov_b32 v47, 0
    v_mov_b32 v48, 0
    v_mov_b32 v49, 0
    v_mov_b32 v50, 0
    v_mov_b32 v51, 0
    v_mov_b32 v52, 0
    v_mov_b32 v53, 0
    v_mov_b32 v54, 0
    v_mov_b32 v55, 0
    v_mov_b32 v56, 0
    v_mov_b32 v57, 0
    v_mov_b32 v58, 0
    v_mov_b32 v59, 0
    v_mov_b32 v60, 0
    v_mov_b32 v61, 0
    v_mov_b32 v62, 0
    v_mov_b32 v63, 0
    v_mov_b32 v64, 0
    v_mov_b32 v65, 0
    v_mov_b32 v66, 0
    v_mov_b32 v67, 0
    v_mov_b32 v68, 0
    v_mov_b32 v69, 0
    v_mov_b32 v70, 0
    v_mov_b32 v71, 0
    v_mov_b32 v72, 0
    v_mov_b32 v73, 0
    v_mov_b32 v74, 0
    v_mov_b32 v75, 0
    v_mov_b32 v76, 0
    v_mov_b32 v77, 0
    v_mov_b32 v78, 0
    v_mov_b32 v79, 0
    v_mov_b32 v80, 0
    v_mov_b32 v81, 0
    v_mov_b32 v82, 0
    v_mov_b32 v83, 0
    v_mov_b32 v84, 0
    v_mov_b32 v85, 0
    v_mov_b32 v86, 0
    v_mov_b32 v87, 0
    v_mov_b32 v88, 0
    v_mov_b32 v89, 0
    v_mov_b32 v90, 0
    v_mov_b32 v91, 0
    v_mov_b32 v92, 0
    v_mov_b32 v93, 0
    v_mov_b32 v94, 0
    v_mov_b32 v95, 0
    v_mov_b32 v96, 0
    v_mov_b32 v97, 0
    v_mov_b32 v98, 0
    v_mov_b32 v99, 0
    v_mov_b32 v100, 0
    v_mov_b32 v101, 0
    v_mov_b32 v102, 0
    v_mov_b32 v103, 0
    v_mov_b32 v104, 0
    v_mov_b32 v105, 0
    v_mov_b32 v106, 0
    v_mov_b32 v107, 0
    v_mov_b32 v108, 0
    v_mov_b32 v109, 0
    v_mov_b32 v110, 0
    v_mov_b32 v111, 0
    v_mov_b32 v112, 0
    v_mov_b32 v113, 0
    v_mov_b32 v114, 0
    v_mov_b32 v115, 0
    v_mov_b32 v116, 0
    v_mov_b32 v117, 0
    v_mov_b32 v118, 0
    v_mov_b32 v119, 0
    s_barrier
    ds_read_b128 v[136:139], v3 offset:0
    ds_read_b128 v[120:123], v6 offset:0
    ds_read_b128 v[124:127], v6 offset:2048
    ds_read_b128 v[128:131], v6 offset:4096
    ds_read_b128 v[132:135], v6 offset:6144
    ds_read_b128 v[140:143], v3 offset:2048
    ds_read_b128 v[144:147], v3 offset:4096
    ds_read_b128 v[148:151], v3 offset:6144
    ds_read_b128 v[152:155], v3 offset:8192
    ds_read_b128 v[156:159], v3 offset:10240
    ds_read_b128 v[160:163], v3 offset:12288
.p2align 3
ffn1_cloop:
    s_waitcnt lgkmcnt(9)
    v_mfma_f32_16x16x32_bf16 v[8:11], v[136:139], v[120:123], v[8:11]
    ds_read_b128 v[180:183], v3 offset:1024
    s_waitcnt lgkmcnt(9)
    v_mfma_f32_16x16x32_bf16 v[36:39], v[136:139], v[124:127], v[36:39]
    ds_read_b128 v[164:167], v6 offset:1024
    s_waitcnt lgkmcnt(9)
    v_mfma_f32_16x16x32_bf16 v[64:67], v[136:139], v[128:131], v[64:67]
    ds_read_b128 v[168:171], v6 offset:3072
    s_waitcnt lgkmcnt(9)
    v_mfma_f32_16x16x32_bf16 v[92:95], v[136:139], v[132:135], v[92:95]
    ds_read_b128 v[172:175], v6 offset:5120
    s_waitcnt lgkmcnt(9)
    v_mfma_f32_16x16x32_bf16 v[12:15], v[140:143], v[120:123], v[12:15]
    ds_read_b128 v[176:179], v6 offset:7168
    v_mfma_f32_16x16x32_bf16 v[40:43], v[140:143], v[124:127], v[40:43]
    ds_read_b128 v[184:187], v3 offset:3072
    v_mfma_f32_16x16x32_bf16 v[68:71], v[140:143], v[128:131], v[68:71]
    ds_read_b128 v[188:191], v3 offset:5120
    v_mfma_f32_16x16x32_bf16 v[96:99], v[140:143], v[132:135], v[96:99]
    ds_read_b128 v[192:195], v3 offset:7168
    s_waitcnt lgkmcnt(12)
    v_mfma_f32_16x16x32_bf16 v[16:19], v[144:147], v[120:123], v[16:19]
    ds_read_b128 v[196:199], v3 offset:9216
    v_mfma_f32_16x16x32_bf16 v[44:47], v[144:147], v[124:127], v[44:47]
    ds_read_b128 v[200:203], v3 offset:11264
    v_mfma_f32_16x16x32_bf16 v[72:75], v[144:147], v[128:131], v[72:75]
    ds_read_b128 v[204:207], v3 offset:13312
    v_mfma_f32_16x16x32_bf16 v[100:103], v[144:147], v[132:135], v[100:103]
    s_waitcnt lgkmcnt(14)
    v_mfma_f32_16x16x32_bf16 v[20:23], v[148:151], v[120:123], v[20:23]
    v_mfma_f32_16x16x32_bf16 v[48:51], v[148:151], v[124:127], v[48:51]
    v_mfma_f32_16x16x32_bf16 v[76:79], v[148:151], v[128:131], v[76:79]
    v_mfma_f32_16x16x32_bf16 v[104:107], v[148:151], v[132:135], v[104:107]
    s_waitcnt lgkmcnt(13)
    v_mfma_f32_16x16x32_bf16 v[24:27], v[152:155], v[120:123], v[24:27]
    v_mfma_f32_16x16x32_bf16 v[52:55], v[152:155], v[124:127], v[52:55]
    v_mfma_f32_16x16x32_bf16 v[80:83], v[152:155], v[128:131], v[80:83]
    v_mfma_f32_16x16x32_bf16 v[108:111], v[152:155], v[132:135], v[108:111]
    s_waitcnt lgkmcnt(12)
    v_mfma_f32_16x16x32_bf16 v[28:31], v[156:159], v[120:123], v[28:31]
    v_mfma_f32_16x16x32_bf16 v[56:59], v[156:159], v[124:127], v[56:59]
    v_mfma_f32_16x16x32_bf16 v[84:87], v[156:159], v[128:131], v[84:87]
    v_mfma_f32_16x16x32_bf16 v[112:115], v[156:159], v[132:135], v[112:115]
    s_waitcnt lgkmcnt(11)
    v_mfma_f32_16x16x32_bf16 v[32:35], v[160:163], v[120:123], v[32:35]
    v_mfma_f32_16x16x32_bf16 v[60:63], v[160:163], v[124:127], v[60:63]
    v_mfma_f32_16x16x32_bf16 v[88:91], v[160:163], v[128:131], v[88:91]
    v_mfma_f32_16x16x32_bf16 v[116:119], v[160:163], v[132:135], v[116:119]
    s_waitcnt lgkmcnt(9)
    v_mfma_f32_16x16x32_bf16 v[8:11], v[180:183], v[164:167], v[8:11]
    s_add_u32 s33, s33, 45056
    s_cmp_ge_u32 s33, 135168
    s_cselect_b32 s33, 0, s33
    s_waitcnt lgkmcnt(8)
    v_mfma_f32_16x16x32_bf16 v[36:39], v[180:183], v[168:171], v[36:39]
    s_waitcnt lgkmcnt(7)
    v_mfma_f32_16x16x32_bf16 v[64:67], v[180:183], v[172:175], v[64:67]
    s_waitcnt lgkmcnt(0)
    v_add_u32 v6, s33, v4
    v_add_u32 v3, s33, v5
    s_barrier
    ds_read_b128 v[136:139], v3 offset:0
    v_mfma_f32_16x16x32_bf16 v[92:95], v[180:183], v[176:179], v[92:95]
    ds_read_b128 v[120:123], v6 offset:0
    v_mfma_f32_16x16x32_bf16 v[12:15], v[184:187], v[164:167], v[12:15]
    ds_read_b128 v[124:127], v6 offset:2048
    v_mfma_f32_16x16x32_bf16 v[40:43], v[184:187], v[168:171], v[40:43]
    ds_read_b128 v[128:131], v6 offset:4096
    v_mfma_f32_16x16x32_bf16 v[68:71], v[184:187], v[172:175], v[68:71]
    ds_read_b128 v[132:135], v6 offset:6144
    v_mfma_f32_16x16x32_bf16 v[96:99], v[184:187], v[176:179], v[96:99]
    ds_read_b128 v[140:143], v3 offset:2048
    v_mfma_f32_16x16x32_bf16 v[16:19], v[188:191], v[164:167], v[16:19]
    ds_read_b128 v[144:147], v3 offset:4096
    v_mfma_f32_16x16x32_bf16 v[44:47], v[188:191], v[168:171], v[44:47]
    ds_read_b128 v[148:151], v3 offset:6144
    v_mfma_f32_16x16x32_bf16 v[72:75], v[188:191], v[172:175], v[72:75]
    ds_read_b128 v[152:155], v3 offset:8192
    v_mfma_f32_16x16x32_bf16 v[100:103], v[188:191], v[176:179], v[100:103]
    ds_read_b128 v[156:159], v3 offset:10240
    v_mfma_f32_16x16x32_bf16 v[20:23], v[192:195], v[164:167], v[20:23]
    ds_read_b128 v[160:163], v3 offset:12288
    v_mfma_f32_16x16x32_bf16 v[48:51], v[192:195], v[168:171], v[48:51]
    v_mfma_f32_16x16x32_bf16 v[76:79], v[192:195], v[172:175], v[76:79]
    v_mfma_f32_16x16x32_bf16 v[104:107], v[192:195], v[176:179], v[104:107]
    v_mfma_f32_16x16x32_bf16 v[24:27], v[196:199], v[164:167], v[24:27]
    v_mfma_f32_16x16x32_bf16 v[52:55], v[196:199], v[168:171], v[52:55]
    v_mfma_f32_16x16x32_bf16 v[80:83], v[196:199], v[172:175], v[80:83]
    v_mfma_f32_16x16x32_bf16 v[108:111], v[196:199], v[176:179], v[108:111]
    v_mfma_f32_16x16x32_bf16 v[28:31], v[200:203], v[164:167], v[28:31]
    v_mfma_f32_16x16x32_bf16 v[56:59], v[200:203], v[168:171], v[56:59]
    v_mfma_f32_16x16x32_bf16 v[84:87], v[200:203], v[172:175], v[84:87]
    v_mfma_f32_16x16x32_bf16 v[112:115], v[200:203], v[176:179], v[112:115]
    v_mfma_f32_16x16x32_bf16 v[32:35], v[204:207], v[164:167], v[32:35]
    v_mfma_f32_16x16x32_bf16 v[60:63], v[204:207], v[168:171], v[60:63]
    v_mfma_f32_16x16x32_bf16 v[88:91], v[204:207], v[172:175], v[88:91]
    v_mfma_f32_16x16x32_bf16 v[116:119], v[204:207], v[176:179], v[116:119]
    s_waitcnt lgkmcnt(9)
    v_mfma_f32_16x16x32_bf16 v[8:11], v[136:139], v[120:123], v[8:11]
    ds_read_b128 v[180:183], v3 offset:1024
    s_waitcnt lgkmcnt(9)
    v_mfma_f32_16x16x32_bf16 v[36:39], v[136:139], v[124:127], v[36:39]
    ds_read_b128 v[164:167], v6 offset:1024
    s_waitcnt lgkmcnt(9)
    v_mfma_f32_16x16x32_bf16 v[64:67], v[136:139], v[128:131], v[64:67]
    ds_read_b128 v[168:171], v6 offset:3072
    s_waitcnt lgkmcnt(9)
    v_mfma_f32_16x16x32_bf16 v[92:95], v[136:139], v[132:135], v[92:95]
    ds_read_b128 v[172:175], v6 offset:5120
    s_waitcnt lgkmcnt(9)
    v_mfma_f32_16x16x32_bf16 v[12:15], v[140:143], v[120:123], v[12:15]
    ds_read_b128 v[176:179], v6 offset:7168
    v_mfma_f32_16x16x32_bf16 v[40:43], v[140:143], v[124:127], v[40:43]
    ds_read_b128 v[184:187], v3 offset:3072
    v_mfma_f32_16x16x32_bf16 v[68:71], v[140:143], v[128:131], v[68:71]
    ds_read_b128 v[188:191], v3 offset:5120
    v_mfma_f32_16x16x32_bf16 v[96:99], v[140:143], v[132:135], v[96:99]
    ds_read_b128 v[192:195], v3 offset:7168
    s_waitcnt lgkmcnt(12)
    v_mfma_f32_16x16x32_bf16 v[16:19], v[144:147], v[120:123], v[16:19]
    ds_read_b128 v[196:199], v3 offset:9216
    v_mfma_f32_16x16x32_bf16 v[44:47], v[144:147], v[124:127], v[44:47]
    ds_read_b128 v[200:203], v3 offset:11264
    v_mfma_f32_16x16x32_bf16 v[72:75], v[144:147], v[128:131], v[72:75]
    ds_read_b128 v[204:207], v3 offset:13312
    v_mfma_f32_16x16x32_bf16 v[100:103], v[144:147], v[132:135], v[100:103]
    s_waitcnt lgkmcnt(14)
    v_mfma_f32_16x16x32_bf16 v[20:23], v[148:151], v[120:123], v[20:23]
    v_mfma_f32_16x16x32_bf16 v[48:51], v[148:151], v[124:127], v[48:51]
    v_mfma_f32_16x16x32_bf16 v[76:79], v[148:151], v[128:131], v[76:79]
    v_mfma_f32_16x16x32_bf16 v[104:107], v[148:151], v[132:135], v[104:107]
    s_waitcnt lgkmcnt(13)
    v_mfma_f32_16x16x32_bf16 v[24:27], v[152:155], v[120:123], v[24:27]
    v_mfma_f32_16x16x32_bf16 v[52:55], v[152:155], v[124:127], v[52:55]
    v_mfma_f32_16x16x32_bf16 v[80:83], v[152:155], v[128:131], v[80:83]
    v_mfma_f32_16x16x32_bf16 v[108:111], v[152:155], v[132:135], v[108:111]
    s_waitcnt lgkmcnt(12)
    v_mfma_f32_16x16x32_bf16 v[28:31], v[156:159], v[120:123], v[28:31]
    v_mfma_f32_16x16x32_bf16 v[56:59], v[156:159], v[124:127], v[56:59]
    v_mfma_f32_16x16x32_bf16 v[84:87], v[156:159], v[128:131], v[84:87]
    v_mfma_f32_16x16x32_bf16 v[112:115], v[156:159], v[132:135], v[112:115]
    s_waitcnt lgkmcnt(11)
    v_mfma_f32_16x16x32_bf16 v[32:35], v[160:163], v[120:123], v[32:35]
    v_mfma_f32_16x16x32_bf16 v[60:63], v[160:163], v[124:127], v[60:63]
    v_mfma_f32_16x16x32_bf16 v[88:91], v[160:163], v[128:131], v[88:91]
    v_mfma_f32_16x16x32_bf16 v[116:119], v[160:163], v[132:135], v[116:119]
    s_waitcnt lgkmcnt(9)
    v_mfma_f32_16x16x32_bf16 v[8:11], v[180:183], v[164:167], v[8:11]
    s_add_u32 s33, s33, 45056
    s_cmp_ge_u32 s33, 135168
    s_cselect_b32 s33, 0, s33
    s_waitcnt lgkmcnt(8)
    v_mfma_f32_16x16x32_bf16 v[36:39], v[180:183], v[168:171], v[36:39]
    s_waitcnt lgkmcnt(7)
    v_mfma_f32_16x16x32_bf16 v[64:67], v[180:183], v[172:175], v[64:67]
    s_waitcnt lgkmcnt(0)
    v_add_u32 v6, s33, v4
    v_add_u32 v3, s33, v5
    s_barrier
    ds_read_b128 v[136:139], v3 offset:0
    v_mfma_f32_16x16x32_bf16 v[92:95], v[180:183], v[176:179], v[92:95]
    ds_read_b128 v[120:123], v6 offset:0
    v_mfma_f32_16x16x32_bf16 v[12:15], v[184:187], v[164:167], v[12:15]
    ds_read_b128 v[124:127], v6 offset:2048
    v_mfma_f32_16x16x32_bf16 v[40:43], v[184:187], v[168:171], v[40:43]
    ds_read_b128 v[128:131], v6 offset:4096
    v_mfma_f32_16x16x32_bf16 v[68:71], v[184:187], v[172:175], v[68:71]
    ds_read_b128 v[132:135], v6 offset:6144
    v_mfma_f32_16x16x32_bf16 v[96:99], v[184:187], v[176:179], v[96:99]
    ds_read_b128 v[140:143], v3 offset:2048
    v_mfma_f32_16x16x32_bf16 v[16:19], v[188:191], v[164:167], v[16:19]
    ds_read_b128 v[144:147], v3 offset:4096
    v_mfma_f32_16x16x32_bf16 v[44:47], v[188:191], v[168:171], v[44:47]
    ds_read_b128 v[148:151], v3 offset:6144
    v_mfma_f32_16x16x32_bf16 v[72:75], v[188:191], v[172:175], v[72:75]
    ds_read_b128 v[152:155], v3 offset:8192
    v_mfma_f32_16x16x32_bf16 v[100:103], v[188:191], v[176:179], v[100:103]
    ds_read_b128 v[156:159], v3 offset:10240
    v_mfma_f32_16x16x32_bf16 v[20:23], v[192:195], v[164:167], v[20:23]
    ds_read_b128 v[160:163], v3 offset:12288
    v_mfma_f32_16x16x32_bf16 v[48:51], v[192:195], v[168:171], v[48:51]
    v_mfma_f32_16x16x32_bf16 v[76:79], v[192:195], v[172:175], v[76:79]
    v_mfma_f32_16x16x32_bf16 v[104:107], v[192:195], v[176:179], v[104:107]
    v_mfma_f32_16x16x32_bf16 v[24:27], v[196:199], v[164:167], v[24:27]
    v_mfma_f32_16x16x32_bf16 v[52:55], v[196:199], v[168:171], v[52:55]
    v_mfma_f32_16x16x32_bf16 v[80:83], v[196:199], v[172:175], v[80:83]
    v_mfma_f32_16x16x32_bf16 v[108:111], v[196:199], v[176:179], v[108:111]
    v_mfma_f32_16x16x32_bf16 v[28:31], v[200:203], v[164:167], v[28:31]
    v_mfma_f32_16x16x32_bf16 v[56:59], v[200:203], v[168:171], v[56:59]
    v_mfma_f32_16x16x32_bf16 v[84:87], v[200:203], v[172:175], v[84:87]
    v_mfma_f32_16x16x32_bf16 v[112:115], v[200:203], v[176:179], v[112:115]
    v_mfma_f32_16x16x32_bf16 v[32:35], v[204:207], v[164:167], v[32:35]
    v_mfma_f32_16x16x32_bf16 v[60:63], v[204:207], v[168:171], v[60:63]
    v_mfma_f32_16x16x32_bf16 v[88:91], v[204:207], v[172:175], v[88:91]
    s_sub_u32 s34, s34, 2
    s_cmp_lg_u32 s34, 0
    v_mfma_f32_16x16x32_bf16 v[116:119], v[204:207], v[176:179], v[116:119]
    s_cbranch_scc1 ffn1_cloop
    s_waitcnt lgkmcnt(0)
    s_nop 7
    s_add_u32 s16, s4, 0x1800000
    s_addc_u32 s17, s5, 0
    s_mov_b32 s18, 0xe00000
    s_mov_b32 s19, 0x20000
    s_mul_i32 s3, s40, 448
    s_add_u32 s3, s3, 147456
    v_lshrrev_b32 v3, 4, v0
    v_lshlrev_b32 v3, 4, v3
    v_add_u32 v3, s3, v3
    ds_read_b128 v[120:123], v3 offset:0
    ds_read_b128 v[148:151], v3 offset:1024
    ds_read_b128 v[124:127], v3 offset:64
    ds_read_b128 v[152:155], v3 offset:1088
    ds_read_b128 v[128:131], v3 offset:128
    ds_read_b128 v[156:159], v3 offset:1152
    ds_read_b128 v[132:135], v3 offset:192
    ds_read_b128 v[160:163], v3 offset:1216
    ds_read_b128 v[136:139], v3 offset:256
    ds_read_b128 v[164:167], v3 offset:1280
    ds_read_b128 v[140:143], v3 offset:320
    ds_read_b128 v[168:171], v3 offset:1344
    ds_read_b128 v[144:147], v3 offset:384
    ds_read_b128 v[172:175], v3 offset:1408
    s_lshl_b32 s3, s39, 8
    s_add_u32 s3, s3, 149504
    v_and_b32 v1, 15, v0
    v_lshl_add_u32 v1, v1, 2, s3
    s_waitcnt lgkmcnt(4)
    ds_read_b32 v208, v1 offset:0
    ds_read_b32 v210, v1 offset:512
    ds_read_b32 v216, v1 offset:64
    ds_read_b32 v218, v1 offset:576
    ds_read_b32 v224, v1 offset:128
    ds_read_b32 v226, v1 offset:640
    ds_read_b32 v232, v1 offset:192
    ds_read_b32 v234, v1 offset:704
    s_mul_i32 s41, s31, 917504
    s_lshl_b32 s3, s39, 13
    s_add_u32 s41, s41, s3
    s_mul_i32 s42, s32, 7
    s_lshl_b32 s43, s40, 2
    s_add_u32 s3, s42, s43
    s_add_u32 s3, s3, 0
    s_lshr_b32 s54, s3, 1
    s_lshl_b32 s54, s54, 14
    s_and_b32 s3, s3, 1
    s_lshl_b32 s3, s3, 10
    s_add_u32 s54, s54, s3
    s_add_u32 s54, s54, s41
    s_add_u32 s3, s42, s43
    s_add_u32 s3, s3, 1
    s_lshr_b32 s55, s3, 1
    s_lshl_b32 s55, s55, 14
    s_and_b32 s3, s3, 1
    s_lshl_b32 s3, s3, 10
    s_add_u32 s55, s55, s3
    s_add_u32 s55, s55, s41
    s_add_u32 s3, s42, s43
    s_add_u32 s3, s3, 2
    s_lshr_b32 s56, s3, 1
    s_lshl_b32 s56, s56, 14
    s_and_b32 s3, s3, 1
    s_lshl_b32 s3, s3, 10
    s_add_u32 s56, s56, s3
    s_add_u32 s56, s56, s41
    s_add_u32 s3, s42, 3
    s_lshr_b32 s57, s3, 1
    s_lshl_b32 s57, s57, 14
    s_and_b32 s3, s3, 1
    s_lshl_b32 s3, s3, 10
    s_add_u32 s57, s57, s3
    s_add_u32 s57, s57, s41
    s_lshl_b32 s3, s40, 9
    s_add_u32 s57, s57, s3
    v_add_u32 v7, 4096, v2
    v_and_b32 v6, 15, v0
    v_lshlrev_b32 v6, 4, v6
    v_bfe_u32 v1, v0, 4, 1
    v_lshl_add_u32 v6, v1, 11, v6
    v_lshrrev_b32 v1, 5, v0
    v_lshl_add_u32 v6, v1, 8, v6
    s_mov_b32 s52, 0xbdd2d3e8
    s_mov_b32 s53, 0xbdd2d3e8
    v_mov_b32 v4, 0xc0135761
    v_mov_b32 v5, 0xc0135761
    s_waitcnt lgkmcnt(0)
    s_add_u32 s88, s4, 0x4400000
    s_addc_u32 s89, s5, 0
    s_mov_b32 s90, 0xe1400
    s_mov_b32 s91, 0x20000
    s_lshl_b32 s43, s31, 1
    s_add_u32 s43, s43, s39
    s_lshl_b32 s43, s43, 5
    s_lshl_b32 s3, s32, 1
    s_add_u32 s43, s43, s3
    s_add_u32 s43, s43, s40
    s_lshl_b32 s43, s43, 7
    s_add_u32 s92, s43, 524288
    s_add_u32 s43, s43, 791552
    v_pk_fma_f32 v[8:9], v[120:121], v[208:209], v[8:9] op_sel_hi:[1,0,1]
    v_pk_fma_f32 v[10:11], v[122:123], v[208:209], v[10:11] op_sel_hi:[1,0,1]
    v_pk_fma_f32 v[12:13], v[124:125], v[208:209], v[12:13] op_sel_hi:[1,0,1]
    v_pk_fma_f32 v[14:15], v[126:127], v[208:209], v[14:15] op_sel_hi:[1,0,1]
    v_pk_fma_f32 v[36:37], v[120:121], v[216:217], v[36:37] op_sel_hi:[1,0,1]
    v_pk_fma_f32 v[38:39], v[122:123], v[216:217], v[38:39] op_sel_hi:[1,0,1]
    v_pk_fma_f32 v[40:41], v[124:125], v[216:217], v[40:41] op_sel_hi:[1,0,1]
    v_pk_fma_f32 v[42:43], v[126:127], v[216:217], v[42:43] op_sel_hi:[1,0,1]
    v_pk_fma_f32 v[64:65], v[120:121], v[224:225], v[64:65] op_sel_hi:[1,0,1]
    v_pk_fma_f32 v[66:67], v[122:123], v[224:225], v[66:67] op_sel_hi:[1,0,1]
    v_pk_fma_f32 v[68:69], v[124:125], v[224:225], v[68:69] op_sel_hi:[1,0,1]
    v_pk_fma_f32 v[70:71], v[126:127], v[224:225], v[70:71] op_sel_hi:[1,0,1]
    v_pk_fma_f32 v[92:93], v[120:121], v[232:233], v[92:93] op_sel_hi:[1,0,1]
    v_pk_fma_f32 v[94:95], v[122:123], v[232:233], v[94:95] op_sel_hi:[1,0,1]
    v_pk_fma_f32 v[96:97], v[124:125], v[232:233], v[96:97] op_sel_hi:[1,0,1]
    v_pk_fma_f32 v[98:99], v[126:127], v[232:233], v[98:99] op_sel_hi:[1,0,1]
    v_pk_fma_f32 v[8:9], v[8:9], v[210:211], v[148:149] op_sel_hi:[1,0,1]
    v_pk_fma_f32 v[10:11], v[10:11], v[210:211], v[150:151] op_sel_hi:[1,0,1]
    v_pk_fma_f32 v[12:13], v[12:13], v[210:211], v[152:153] op_sel_hi:[1,0,1]
    v_pk_fma_f32 v[14:15], v[14:15], v[210:211], v[154:155] op_sel_hi:[1,0,1]
    v_pk_fma_f32 v[36:37], v[36:37], v[218:219], v[148:149] op_sel_hi:[1,0,1]
    v_pk_fma_f32 v[38:39], v[38:39], v[218:219], v[150:151] op_sel_hi:[1,0,1]
    v_pk_fma_f32 v[40:41], v[40:41], v[218:219], v[152:153] op_sel_hi:[1,0,1]
    v_pk_fma_f32 v[42:43], v[42:43], v[218:219], v[154:155] op_sel_hi:[1,0,1]
    v_pk_fma_f32 v[64:65], v[64:65], v[226:227], v[148:149] op_sel_hi:[1,0,1]
    v_pk_fma_f32 v[66:67], v[66:67], v[226:227], v[150:151] op_sel_hi:[1,0,1]
    v_pk_fma_f32 v[68:69], v[68:69], v[226:227], v[152:153] op_sel_hi:[1,0,1]
    v_pk_fma_f32 v[70:71], v[70:71], v[226:227], v[154:155] op_sel_hi:[1,0,1]
    v_pk_fma_f32 v[92:93], v[92:93], v[234:235], v[148:149] op_sel_hi:[1,0,1]
    v_pk_fma_f32 v[94:95], v[94:95], v[234:235], v[150:151] op_sel_hi:[1,0,1]
    v_pk_fma_f32 v[96:97], v[96:97], v[234:235], v[152:153] op_sel_hi:[1,0,1]
    v_pk_fma_f32 v[98:99], v[98:99], v[234:235], v[154:155] op_sel_hi:[1,0,1]
    v_pk_mul_f32 v[176:177], v[8:9], v[8:9]
    v_pk_mul_f32 v[178:179], v[10:11], v[10:11]
    v_pk_mul_f32 v[180:181], v[12:13], v[12:13]
    v_pk_mul_f32 v[182:183], v[14:15], v[14:15]
    v_pk_mul_f32 v[184:185], v[36:37], v[36:37]
    v_pk_mul_f32 v[186:187], v[38:39], v[38:39]
    v_pk_mul_f32 v[188:189], v[40:41], v[40:41]
    v_pk_mul_f32 v[190:191], v[42:43], v[42:43]
    v_pk_mul_f32 v[192:193], v[64:65], v[64:65]
    v_pk_mul_f32 v[194:195], v[66:67], v[66:67]
    v_pk_mul_f32 v[196:197], v[68:69], v[68:69]
    v_pk_mul_f32 v[198:199], v[70:71], v[70:71]
    v_pk_mul_f32 v[200:201], v[92:93], v[92:93]
    v_pk_mul_f32 v[202:203], v[94:95], v[94:95]
    v_pk_mul_f32 v[204:205], v[96:97], v[96:97]
    v_pk_mul_f32 v[206:207], v[98:99], v[98:99]
    v_pk_fma_f32 v[176:177], v[176:177], s[52:53], v[4:5]
    v_pk_fma_f32 v[178:179], v[178:179], s[52:53], v[4:5]
    v_pk_fma_f32 v[180:181], v[180:181], s[52:53], v[4:5]
    v_pk_fma_f32 v[182:183], v[182:183], s[52:53], v[4:5]
    v_pk_fma_f32 v[184:185], v[184:185], s[52:53], v[4:5]
    v_pk_fma_f32 v[186:187], v[186:187], s[52:53], v[4:5]
    v_pk_fma_f32 v[188:189], v[188:189], s[52:53], v[4:5]
    v_pk_fma_f32 v[190:191], v[190:191], s[52:53], v[4:5]
    v_pk_fma_f32 v[192:193], v[192:193], s[52:53], v[4:5]
    v_pk_fma_f32 v[194:195], v[194:195], s[52:53], v[4:5]
    v_pk_fma_f32 v[196:197], v[196:197], s[52:53], v[4:5]
    v_pk_fma_f32 v[198:199], v[198:199], s[52:53], v[4:5]
    v_pk_fma_f32 v[200:201], v[200:201], s[52:53], v[4:5]
    v_pk_fma_f32 v[202:203], v[202:203], s[52:53], v[4:5]
    v_pk_fma_f32 v[204:205], v[204:205], s[52:53], v[4:5]
    v_pk_fma_f32 v[206:207], v[206:207], s[52:53], v[4:5]
    v_pk_mul_f32 v[176:177], v[176:177], v[8:9]
    v_pk_mul_f32 v[178:179], v[178:179], v[10:11]
    v_pk_mul_f32 v[180:181], v[180:181], v[12:13]
    v_pk_mul_f32 v[182:183], v[182:183], v[14:15]
    v_pk_mul_f32 v[184:185], v[184:185], v[36:37]
    v_pk_mul_f32 v[186:187], v[186:187], v[38:39]
    v_pk_mul_f32 v[188:189], v[188:189], v[40:41]
    v_pk_mul_f32 v[190:191], v[190:191], v[42:43]
    v_pk_mul_f32 v[192:193], v[192:193], v[64:65]
    v_pk_mul_f32 v[194:195], v[194:195], v[66:67]
    v_pk_mul_f32 v[196:197], v[196:197], v[68:69]
    v_pk_mul_f32 v[198:199], v[198:199], v[70:71]
    v_pk_mul_f32 v[200:201], v[200:201], v[92:93]
    v_pk_mul_f32 v[202:203], v[202:203], v[94:95]
    v_pk_mul_f32 v[204:205], v[204:205], v[96:97]
    v_pk_mul_f32 v[206:207], v[206:207], v[98:99]
    v_exp_f32 v176, v176
    v_exp_f32 v177, v177
    v_exp_f32 v178, v178
    v_exp_f32 v179, v179
    v_exp_f32 v180, v180
    v_exp_f32 v181, v181
    v_exp_f32 v182, v182
    v_exp_f32 v183, v183
    v_exp_f32 v184, v184
    v_exp_f32 v185, v185
    v_exp_f32 v186, v186
    v_exp_f32 v187, v187
    v_exp_f32 v188, v188
    v_exp_f32 v189, v189
    v_exp_f32 v190, v190
    v_exp_f32 v191, v191
    v_exp_f32 v192, v192
    v_exp_f32 v193, v193
    v_exp_f32 v194, v194
    v_exp_f32 v195, v195
    v_exp_f32 v196, v196
    v_exp_f32 v197, v197
    v_exp_f32 v198, v198
    v_exp_f32 v199, v199
    v_exp_f32 v200, v200
    v_exp_f32 v201, v201
    v_exp_f32 v202, v202
    v_exp_f32 v203, v203
    v_exp_f32 v204, v204
    v_exp_f32 v205, v205
    v_exp_f32 v206, v206
    v_exp_f32 v207, v207
    v_pk_add_f32 v[176:177], v[176:177], 1.0 op_sel_hi:[1,0]
    v_pk_add_f32 v[178:179], v[178:179], 1.0 op_sel_hi:[1,0]
    v_pk_add_f32 v[180:181], v[180:181], 1.0 op_sel_hi:[1,0]
    v_pk_add_f32 v[182:183], v[182:183], 1.0 op_sel_hi:[1,0]
    v_pk_add_f32 v[184:185], v[184:185], 1.0 op_sel_hi:[1,0]
    v_pk_add_f32 v[186:187], v[186:187], 1.0 op_sel_hi:[1,0]
    v_pk_add_f32 v[188:189], v[188:189], 1.0 op_sel_hi:[1,0]
    v_pk_add_f32 v[190:191], v[190:191], 1.0 op_sel_hi:[1,0]
    v_pk_add_f32 v[192:193], v[192:193], 1.0 op_sel_hi:[1,0]
    v_pk_add_f32 v[194:195], v[194:195], 1.0 op_sel_hi:[1,0]
    v_pk_add_f32 v[196:197], v[196:197], 1.0 op_sel_hi:[1,0]
    v_pk_add_f32 v[198:199], v[198:199], 1.0 op_sel_hi:[1,0]
    v_pk_add_f32 v[200:201], v[200:201], 1.0 op_sel_hi:[1,0]
    v_pk_add_f32 v[202:203], v[202:203], 1.0 op_sel_hi:[1,0]
    v_pk_add_f32 v[204:205], v[204:205], 1.0 op_sel_hi:[1,0]
    v_pk_add_f32 v[206:207], v[206:207], 1.0 op_sel_hi:[1,0]
    v_rcp_f32 v176, v176
    v_rcp_f32 v177, v177
    v_rcp_f32 v178, v178
    v_rcp_f32 v179, v179
    v_rcp_f32 v180, v180
    v_rcp_f32 v181, v181
    v_rcp_f32 v182, v182
    v_rcp_f32 v183, v183
    v_rcp_f32 v184, v184
    v_rcp_f32 v185, v185
    v_rcp_f32 v186, v186
    v_rcp_f32 v187, v187
    v_rcp_f32 v188, v188
    v_rcp_f32 v189, v189
    v_rcp_f32 v190, v190
    v_rcp_f32 v191, v191
    v_rcp_f32 v192, v192
    v_rcp_f32 v193, v193
    v_rcp_f32 v194, v194
    v_rcp_f32 v195, v195
    v_rcp_f32 v196, v196
    v_rcp_f32 v197, v197
    v_rcp_f32 v198, v198
    v_rcp_f32 v199, v199
    v_rcp_f32 v200, v200
    v_rcp_f32 v201, v201
    v_rcp_f32 v202, v202
    v_rcp_f32 v203, v203
    v_rcp_f32 v204, v204
    v_rcp_f32 v205, v205
    v_rcp_f32 v206, v206
    v_rcp_f32 v207, v207
    v_pk_mul_f32 v[176:177], v[176:177], v[8:9]
    v_pk_mul_f32 v[178:179], v[178:179], v[10:11]
    v_pk_mul_f32 v[180:181], v[180:181], v[12:13]
    v_pk_mul_f32 v[182:183], v[182:183], v[14:15]
    v_pk_mul_f32 v[184:185], v[184:185], v[36:37]
    v_pk_mul_f32 v[186:187], v[186:187], v[38:39]
    v_pk_mul_f32 v[188:189], v[188:189], v[40:41]
    v_pk_mul_f32 v[190:191], v[190:191], v[42:43]
    v_pk_mul_f32 v[192:193], v[192:193], v[64:65]
    v_pk_mul_f32 v[194:195], v[194:195], v[66:67]
    v_pk_mul_f32 v[196:197], v[196:197], v[68:69]
    v_pk_mul_f32 v[198:199], v[198:199], v[70:71]
    v_pk_mul_f32 v[200:201], v[200:201], v[92:93]
    v_pk_mul_f32 v[202:203], v[202:203], v[94:95]
    v_pk_mul_f32 v[204:205], v[204:205], v[96:97]
    v_pk_mul_f32 v[206:207], v[206:207], v[98:99]
    v_cvt_pk_bf16_f32 v8, v176, v177
    v_cvt_pk_bf16_f32 v9, v178, v179
    v_cvt_pk_bf16_f32 v10, v180, v181
    v_cvt_pk_bf16_f32 v11, v182, v183
    buffer_store_dwordx4 v[8:11], v2, s[16:19], s54 offen offset:0 sc1
    v_cvt_pk_bf16_f32 v36, v184, v185
    v_cvt_pk_bf16_f32 v37, v186, v187
    v_cvt_pk_bf16_f32 v38, v188, v189
    v_cvt_pk_bf16_f32 v39, v190, v191
    buffer_store_dwordx4 v[36:39], v2, s[16:19], s54 offen offset:2048 sc1
    v_cvt_pk_bf16_f32 v64, v192, v193
    v_cvt_pk_bf16_f32 v65, v194, v195
    v_cvt_pk_bf16_f32 v66, v196, v197
    v_cvt_pk_bf16_f32 v67, v198, v199
    buffer_store_dwordx4 v[64:67], v7, s[16:19], s54 offen offset:0 sc1
    v_cvt_pk_bf16_f32 v92, v200, v201
    v_cvt_pk_bf16_f32 v93, v202, v203
    v_cvt_pk_bf16_f32 v94, v204, v205
    v_cvt_pk_bf16_f32 v95, v206, v207
    buffer_store_dwordx4 v[92:95], v7, s[16:19], s54 offen offset:2048 sc1
    v_pk_fma_f32 v[16:17], v[128:129], v[208:209], v[16:17] op_sel_hi:[1,0,1]
    v_pk_fma_f32 v[18:19], v[130:131], v[208:209], v[18:19] op_sel_hi:[1,0,1]
    v_pk_fma_f32 v[20:21], v[132:133], v[208:209], v[20:21] op_sel_hi:[1,0,1]
    v_pk_fma_f32 v[22:23], v[134:135], v[208:209], v[22:23] op_sel_hi:[1,0,1]
    v_pk_fma_f32 v[44:45], v[128:129], v[216:217], v[44:45] op_sel_hi:[1,0,1]
    v_pk_fma_f32 v[46:47], v[130:131], v[216:217], v[46:47] op_sel_hi:[1,0,1]
    v_pk_fma_f32 v[48:49], v[132:133], v[216:217], v[48:49] op_sel_hi:[1,0,1]
    v_pk_fma_f32 v[50:51], v[134:135], v[216:217], v[50:51] op_sel_hi:[1,0,1]
    v_pk_fma_f32 v[72:73], v[128:129], v[224:225], v[72:73] op_sel_hi:[1,0,1]
    v_pk_fma_f32 v[74:75], v[130:131], v[224:225], v[74:75] op_sel_hi:[1,0,1]
    v_pk_fma_f32 v[76:77], v[132:133], v[224:225], v[76:77] op_sel_hi:[1,0,1]
    v_pk_fma_f32 v[78:79], v[134:135], v[224:225], v[78:79] op_sel_hi:[1,0,1]
    v_pk_fma_f32 v[100:101], v[128:129], v[232:233], v[100:101] op_sel_hi:[1,0,1]
    v_pk_fma_f32 v[102:103], v[130:131], v[232:233], v[102:103] op_sel_hi:[1,0,1]
    v_pk_fma_f32 v[104:105], v[132:133], v[232:233], v[104:105] op_sel_hi:[1,0,1]
    v_pk_fma_f32 v[106:107], v[134:135], v[232:233], v[106:107] op_sel_hi:[1,0,1]
    v_pk_fma_f32 v[16:17], v[16:17], v[210:211], v[156:157] op_sel_hi:[1,0,1]
    v_pk_fma_f32 v[18:19], v[18:19], v[210:211], v[158:159] op_sel_hi:[1,0,1]
    v_pk_fma_f32 v[20:21], v[20:21], v[210:211], v[160:161] op_sel_hi:[1,0,1]
    v_pk_fma_f32 v[22:23], v[22:23], v[210:211], v[162:163] op_sel_hi:[1,0,1]
    v_pk_fma_f32 v[44:45], v[44:45], v[218:219], v[156:157] op_sel_hi:[1,0,1]
    v_pk_fma_f32 v[46:47], v[46:47], v[218:219], v[158:159] op_sel_hi:[1,0,1]
    v_pk_fma_f32 v[48:49], v[48:49], v[218:219], v[160:161] op_sel_hi:[1,0,1]
    v_pk_fma_f32 v[50:51], v[50:51], v[218:219], v[162:163] op_sel_hi:[1,0,1]
    v_pk_fma_f32 v[72:73], v[72:73], v[226:227], v[156:157] op_sel_hi:[1,0,1]
    v_pk_fma_f32 v[74:75], v[74:75], v[226:227], v[158:159] op_sel_hi:[1,0,1]
    v_pk_fma_f32 v[76:77], v[76:77], v[226:227], v[160:161] op_sel_hi:[1,0,1]
    v_pk_fma_f32 v[78:79], v[78:79], v[226:227], v[162:163] op_sel_hi:[1,0,1]
    v_pk_fma_f32 v[100:101], v[100:101], v[234:235], v[156:157] op_sel_hi:[1,0,1]
    v_pk_fma_f32 v[102:103], v[102:103], v[234:235], v[158:159] op_sel_hi:[1,0,1]
    v_pk_fma_f32 v[104:105], v[104:105], v[234:235], v[160:161] op_sel_hi:[1,0,1]
    v_pk_fma_f32 v[106:107], v[106:107], v[234:235], v[162:163] op_sel_hi:[1,0,1]
    v_pk_mul_f32 v[176:177], v[16:17], v[16:17]
    v_pk_mul_f32 v[178:179], v[18:19], v[18:19]
    v_pk_mul_f32 v[180:181], v[20:21], v[20:21]
    v_pk_mul_f32 v[182:183], v[22:23], v[22:23]
    v_pk_mul_f32 v[184:185], v[44:45], v[44:45]
    v_pk_mul_f32 v[186:187], v[46:47], v[46:47]
    v_pk_mul_f32 v[188:189], v[48:49], v[48:49]
    v_pk_mul_f32 v[190:191], v[50:51], v[50:51]
    v_pk_mul_f32 v[192:193], v[72:73], v[72:73]
    v_pk_mul_f32 v[194:195], v[74:75], v[74:75]
    v_pk_mul_f32 v[196:197], v[76:77], v[76:77]
    v_pk_mul_f32 v[198:199], v[78:79], v[78:79]
    v_pk_mul_f32 v[200:201], v[100:101], v[100:101]
    v_pk_mul_f32 v[202:203], v[102:103], v[102:103]
    v_pk_mul_f32 v[204:205], v[104:105], v[104:105]
    v_pk_mul_f32 v[206:207], v[106:107], v[106:107]
    v_pk_fma_f32 v[176:177], v[176:177], s[52:53], v[4:5]
    v_pk_fma_f32 v[178:179], v[178:179], s[52:53], v[4:5]
    v_pk_fma_f32 v[180:181], v[180:181], s[52:53], v[4:5]
    v_pk_fma_f32 v[182:183], v[182:183], s[52:53], v[4:5]
    v_pk_fma_f32 v[184:185], v[184:185], s[52:53], v[4:5]
    v_pk_fma_f32 v[186:187], v[186:187], s[52:53], v[4:5]
    v_pk_fma_f32 v[188:189], v[188:189], s[52:53], v[4:5]
    v_pk_fma_f32 v[190:191], v[190:191], s[52:53], v[4:5]
    v_pk_fma_f32 v[192:193], v[192:193], s[52:53], v[4:5]
    v_pk_fma_f32 v[194:195], v[194:195], s[52:53], v[4:5]
    v_pk_fma_f32 v[196:197], v[196:197], s[52:53], v[4:5]
    v_pk_fma_f32 v[198:199], v[198:199], s[52:53], v[4:5]
    v_pk_fma_f32 v[200:201], v[200:201], s[52:53], v[4:5]
    v_pk_fma_f32 v[202:203], v[202:203], s[52:53], v[4:5]
    v_pk_fma_f32 v[204:205], v[204:205], s[52:53], v[4:5]
    v_pk_fma_f32 v[206:207], v[206:207], s[52:53], v[4:5]
    v_pk_mul_f32 v[176:177], v[176:177], v[16:17]
    v_pk_mul_f32 v[178:179], v[178:179], v[18:19]
    v_pk_mul_f32 v[180:181], v[180:181], v[20:21]
    v_pk_mul_f32 v[182:183], v[182:183], v[22:23]
    v_pk_mul_f32 v[184:185], v[184:185], v[44:45]
    v_pk_mul_f32 v[186:187], v[186:187], v[46:47]
    v_pk_mul_f32 v[188:189], v[188:189], v[48:49]
    v_pk_mul_f32 v[190:191], v[190:191], v[50:51]
    v_pk_mul_f32 v[192:193], v[192:193], v[72:73]
    v_pk_mul_f32 v[194:195], v[194:195], v[74:75]
    v_pk_mul_f32 v[196:197], v[196:197], v[76:77]
    v_pk_mul_f32 v[198:199], v[198:199], v[78:79]
    v_pk_mul_f32 v[200:201], v[200:201], v[100:101]
    v_pk_mul_f32 v[202:203], v[202:203], v[102:103]
    v_pk_mul_f32 v[204:205], v[204:205], v[104:105]
    v_pk_mul_f32 v[206:207], v[206:207], v[106:107]
    v_exp_f32 v176, v176
    v_exp_f32 v177, v177
    v_exp_f32 v178, v178
    v_exp_f32 v179, v179
    v_exp_f32 v180, v180
    v_exp_f32 v181, v181
    v_exp_f32 v182, v182
    v_exp_f32 v183, v183
    v_exp_f32 v184, v184
    v_exp_f32 v185, v185
    v_exp_f32 v186, v186
    v_exp_f32 v187, v187
    v_exp_f32 v188, v188
    v_exp_f32 v189, v189
    v_exp_f32 v190, v190
    v_exp_f32 v191, v191
    v_exp_f32 v192, v192
    v_exp_f32 v193, v193
    v_exp_f32 v194, v194
    v_exp_f32 v195, v195
    v_exp_f32 v196, v196
    v_exp_f32 v197, v197
    v_exp_f32 v198, v198
    v_exp_f32 v199, v199
    v_exp_f32 v200, v200
    v_exp_f32 v201, v201
    v_exp_f32 v202, v202
    v_exp_f32 v203, v203
    v_exp_f32 v204, v204
    v_exp_f32 v205, v205
    v_exp_f32 v206, v206
    v_exp_f32 v207, v207
    v_pk_add_f32 v[176:177], v[176:177], 1.0 op_sel_hi:[1,0]
    v_pk_add_f32 v[178:179], v[178:179], 1.0 op_sel_hi:[1,0]
    v_pk_add_f32 v[180:181], v[180:181], 1.0 op_sel_hi:[1,0]
    v_pk_add_f32 v[182:183], v[182:183], 1.0 op_sel_hi:[1,0]
    v_pk_add_f32 v[184:185], v[184:185], 1.0 op_sel_hi:[1,0]
    v_pk_add_f32 v[186:187], v[186:187], 1.0 op_sel_hi:[1,0]
    v_pk_add_f32 v[188:189], v[188:189], 1.0 op_sel_hi:[1,0]
    v_pk_add_f32 v[190:191], v[190:191], 1.0 op_sel_hi:[1,0]
    v_pk_add_f32 v[192:193], v[192:193], 1.0 op_sel_hi:[1,0]
    v_pk_add_f32 v[194:195], v[194:195], 1.0 op_sel_hi:[1,0]
    v_pk_add_f32 v[196:197], v[196:197], 1.0 op_sel_hi:[1,0]
    v_pk_add_f32 v[198:199], v[198:199], 1.0 op_sel_hi:[1,0]
    v_pk_add_f32 v[200:201], v[200:201], 1.0 op_sel_hi:[1,0]
    v_pk_add_f32 v[202:203], v[202:203], 1.0 op_sel_hi:[1,0]
    v_pk_add_f32 v[204:205], v[204:205], 1.0 op_sel_hi:[1,0]
    v_pk_add_f32 v[206:207], v[206:207], 1.0 op_sel_hi:[1,0]
    v_rcp_f32 v176, v176
    v_rcp_f32 v177, v177
    v_rcp_f32 v178, v178
    v_rcp_f32 v179, v179
    v_rcp_f32 v180, v180
    v_rcp_f32 v181, v181
    v_rcp_f32 v182, v182
    v_rcp_f32 v183, v183
    v_rcp_f32 v184, v184
    v_rcp_f32 v185, v185
    v_rcp_f32 v186, v186
    v_rcp_f32 v187, v187
    v_rcp_f32 v188, v188
    v_rcp_f32 v189, v189
    v_rcp_f32 v190, v190
    v_rcp_f32 v191, v191
    v_rcp_f32 v192, v192
    v_rcp_f32 v193, v193
    v_rcp_f32 v194, v194
    v_rcp_f32 v195, v195
    v_rcp_f32 v196, v196
    v_rcp_f32 v197, v197
    v_rcp_f32 v198, v198
    v_rcp_f32 v199, v199
    v_rcp_f32 v200, v200
    v_rcp_f32 v201, v201
    v_rcp_f32 v202, v202
    v_rcp_f32 v203, v203
    v_rcp_f32 v204, v204
    v_rcp_f32 v205, v205
    v_rcp_f32 v206, v206
    v_rcp_f32 v207, v207
    v_pk_mul_f32 v[176:177], v[176:177], v[16:17]
    v_pk_mul_f32 v[178:179], v[178:179], v[18:19]
    v_pk_mul_f32 v[180:181], v[180:181], v[20:21]
    v_pk_mul_f32 v[182:183], v[182:183], v[22:23]
    v_pk_mul_f32 v[184:185], v[184:185], v[44:45]
    v_pk_mul_f32 v[186:187], v[186:187], v[46:47]
    v_pk_mul_f32 v[188:189], v[188:189], v[48:49]
    v_pk_mul_f32 v[190:191], v[190:191], v[50:51]
    v_pk_mul_f32 v[192:193], v[192:193], v[72:73]
    v_pk_mul_f32 v[194:195], v[194:195], v[74:75]
    v_pk_mul_f32 v[196:197], v[196:197], v[76:77]
    v_pk_mul_f32 v[198:199], v[198:199], v[78:79]
    v_pk_mul_f32 v[200:201], v[200:201], v[100:101]
    v_pk_mul_f32 v[202:203], v[202:203], v[102:103]
    v_pk_mul_f32 v[204:205], v[204:205], v[104:105]
    v_pk_mul_f32 v[206:207], v[206:207], v[106:107]
    v_cvt_pk_bf16_f32 v16, v176, v177
    v_cvt_pk_bf16_f32 v17, v178, v179
    v_cvt_pk_bf16_f32 v18, v180, v181
    v_cvt_pk_bf16_f32 v19, v182, v183
    buffer_store_dwordx4 v[16:19], v2, s[16:19], s55 offen offset:0 sc1
    v_cvt_pk_bf16_f32 v44, v184, v185
    v_cvt_pk_bf16_f32 v45, v186, v187
    v_cvt_pk_bf16_f32 v46, v188, v189
    v_cvt_pk_bf16_f32 v47, v190, v191
    buffer_store_dwordx4 v[44:47], v2, s[16:19], s55 offen offset:2048 sc1
    v_cvt_pk_bf16_f32 v72, v192, v193
    v_cvt_pk_bf16_f32 v73, v194, v195
    v_cvt_pk_bf16_f32 v74, v196, v197
    v_cvt_pk_bf16_f32 v75, v198, v199
    buffer_store_dwordx4 v[72:75], v7, s[16:19], s55 offen offset:0 sc1
    v_cvt_pk_bf16_f32 v100, v200, v201
    v_cvt_pk_bf16_f32 v101, v202, v203
    v_cvt_pk_bf16_f32 v102, v204, v205
    v_cvt_pk_bf16_f32 v103, v206, v207
    buffer_store_dwordx4 v[100:103], v7, s[16:19], s55 offen offset:2048 sc1
    v_pk_fma_f32 v[24:25], v[136:137], v[208:209], v[24:25] op_sel_hi:[1,0,1]
    v_pk_fma_f32 v[26:27], v[138:139], v[208:209], v[26:27] op_sel_hi:[1,0,1]
    v_pk_fma_f32 v[28:29], v[140:141], v[208:209], v[28:29] op_sel_hi:[1,0,1]
    v_pk_fma_f32 v[30:31], v[142:143], v[208:209], v[30:31] op_sel_hi:[1,0,1]
    v_pk_fma_f32 v[52:53], v[136:137], v[216:217], v[52:53] op_sel_hi:[1,0,1]
    v_pk_fma_f32 v[54:55], v[138:139], v[216:217], v[54:55] op_sel_hi:[1,0,1]
    v_pk_fma_f32 v[56:57], v[140:141], v[216:217], v[56:57] op_sel_hi:[1,0,1]
    v_pk_fma_f32 v[58:59], v[142:143], v[216:217], v[58:59] op_sel_hi:[1,0,1]
    v_pk_fma_f32 v[80:81], v[136:137], v[224:225], v[80:81] op_sel_hi:[1,0,1]
    v_pk_fma_f32 v[82:83], v[138:139], v[224:225], v[82:83] op_sel_hi:[1,0,1]
    v_pk_fma_f32 v[84:85], v[140:141], v[224:225], v[84:85] op_sel_hi:[1,0,1]
    v_pk_fma_f32 v[86:87], v[142:143], v[224:225], v[86:87] op_sel_hi:[1,0,1]
    v_pk_fma_f32 v[108:109], v[136:137], v[232:233], v[108:109] op_sel_hi:[1,0,1]
    v_pk_fma_f32 v[110:111], v[138:139], v[232:233], v[110:111] op_sel_hi:[1,0,1]
    v_pk_fma_f32 v[112:113], v[140:141], v[232:233], v[112:113] op_sel_hi:[1,0,1]
    v_pk_fma_f32 v[114:115], v[142:143], v[232:233], v[114:115] op_sel_hi:[1,0,1]
    v_pk_fma_f32 v[24:25], v[24:25], v[210:211], v[164:165] op_sel_hi:[1,0,1]
    v_pk_fma_f32 v[26:27], v[26:27], v[210:211], v[166:167] op_sel_hi:[1,0,1]
    v_pk_fma_f32 v[28:29], v[28:29], v[210:211], v[168:169] op_sel_hi:[1,0,1]
    v_pk_fma_f32 v[30:31], v[30:31], v[210:211], v[170:171] op_sel_hi:[1,0,1]
    v_pk_fma_f32 v[52:53], v[52:53], v[218:219], v[164:165] op_sel_hi:[1,0,1]
    v_pk_fma_f32 v[54:55], v[54:55], v[218:219], v[166:167] op_sel_hi:[1,0,1]
    v_pk_fma_f32 v[56:57], v[56:57], v[218:219], v[168:169] op_sel_hi:[1,0,1]
    v_pk_fma_f32 v[58:59], v[58:59], v[218:219], v[170:171] op_sel_hi:[1,0,1]
    v_pk_fma_f32 v[80:81], v[80:81], v[226:227], v[164:165] op_sel_hi:[1,0,1]
    v_pk_fma_f32 v[82:83], v[82:83], v[226:227], v[166:167] op_sel_hi:[1,0,1]
    v_pk_fma_f32 v[84:85], v[84:85], v[226:227], v[168:169] op_sel_hi:[1,0,1]
    v_pk_fma_f32 v[86:87], v[86:87], v[226:227], v[170:171] op_sel_hi:[1,0,1]
    v_pk_fma_f32 v[108:109], v[108:109], v[234:235], v[164:165] op_sel_hi:[1,0,1]
    v_pk_fma_f32 v[110:111], v[110:111], v[234:235], v[166:167] op_sel_hi:[1,0,1]
    v_pk_fma_f32 v[112:113], v[112:113], v[234:235], v[168:169] op_sel_hi:[1,0,1]
    v_pk_fma_f32 v[114:115], v[114:115], v[234:235], v[170:171] op_sel_hi:[1,0,1]
    v_pk_mul_f32 v[176:177], v[24:25], v[24:25]
    v_pk_mul_f32 v[178:179], v[26:27], v[26:27]
    v_pk_mul_f32 v[180:181], v[28:29], v[28:29]
    v_pk_mul_f32 v[182:183], v[30:31], v[30:31]
    v_pk_mul_f32 v[184:185], v[52:53], v[52:53]
    v_pk_mul_f32 v[186:187], v[54:55], v[54:55]
    v_pk_mul_f32 v[188:189], v[56:57], v[56:57]
    v_pk_mul_f32 v[190:191], v[58:59], v[58:59]
    v_pk_mul_f32 v[192:193], v[80:81], v[80:81]
    v_pk_mul_f32 v[194:195], v[82:83], v[82:83]
    v_pk_mul_f32 v[196:197], v[84:85], v[84:85]
    v_pk_mul_f32 v[198:199], v[86:87], v[86:87]
    v_pk_mul_f32 v[200:201], v[108:109], v[108:109]
    v_pk_mul_f32 v[202:203], v[110:111], v[110:111]
    v_pk_mul_f32 v[204:205], v[112:113], v[112:113]
    v_pk_mul_f32 v[206:207], v[114:115], v[114:115]
    v_pk_fma_f32 v[176:177], v[176:177], s[52:53], v[4:5]
    v_pk_fma_f32 v[178:179], v[178:179], s[52:53], v[4:5]
    v_pk_fma_f32 v[180:181], v[180:181], s[52:53], v[4:5]
    v_pk_fma_f32 v[182:183], v[182:183], s[52:53], v[4:5]
    v_pk_fma_f32 v[184:185], v[184:185], s[52:53], v[4:5]
    v_pk_fma_f32 v[186:187], v[186:187], s[52:53], v[4:5]
    v_pk_fma_f32 v[188:189], v[188:189], s[52:53], v[4:5]
    v_pk_fma_f32 v[190:191], v[190:191], s[52:53], v[4:5]
    v_pk_fma_f32 v[192:193], v[192:193], s[52:53], v[4:5]
    v_pk_fma_f32 v[194:195], v[194:195], s[52:53], v[4:5]
    v_pk_fma_f32 v[196:197], v[196:197], s[52:53], v[4:5]
    v_pk_fma_f32 v[198:199], v[198:199], s[52:53], v[4:5]
    v_pk_fma_f32 v[200:201], v[200:201], s[52:53], v[4:5]
    v_pk_fma_f32 v[202:203], v[202:203], s[52:53], v[4:5]
    v_pk_fma_f32 v[204:205], v[204:205], s[52:53], v[4:5]
    v_pk_fma_f32 v[206:207], v[206:207], s[52:53], v[4:5]
    v_pk_mul_f32 v[176:177], v[176:177], v[24:25]
    v_pk_mul_f32 v[178:179], v[178:179], v[26:27]
    v_pk_mul_f32 v[180:181], v[180:181], v[28:29]
    v_pk_mul_f32 v[182:183], v[182:183], v[30:31]
    v_pk_mul_f32 v[184:185], v[184:185], v[52:53]
    v_pk_mul_f32 v[186:187], v[186:187], v[54:55]
    v_pk_mul_f32 v[188:189], v[188:189], v[56:57]
    v_pk_mul_f32 v[190:191], v[190:191], v[58:59]
    v_pk_mul_f32 v[192:193], v[192:193], v[80:81]
    v_pk_mul_f32 v[194:195], v[194:195], v[82:83]
    v_pk_mul_f32 v[196:197], v[196:197], v[84:85]
    v_pk_mul_f32 v[198:199], v[198:199], v[86:87]
    v_pk_mul_f32 v[200:201], v[200:201], v[108:109]
    v_pk_mul_f32 v[202:203], v[202:203], v[110:111]
    v_pk_mul_f32 v[204:205], v[204:205], v[112:113]
    v_pk_mul_f32 v[206:207], v[206:207], v[114:115]
    v_exp_f32 v176, v176
    v_exp_f32 v177, v177
    v_exp_f32 v178, v178
    v_exp_f32 v179, v179
    v_exp_f32 v180, v180
    v_exp_f32 v181, v181
    v_exp_f32 v182, v182
    v_exp_f32 v183, v183
    v_exp_f32 v184, v184
    v_exp_f32 v185, v185
    v_exp_f32 v186, v186
    v_exp_f32 v187, v187
    v_exp_f32 v188, v188
    v_exp_f32 v189, v189
    v_exp_f32 v190, v190
    v_exp_f32 v191, v191
    v_exp_f32 v192, v192
    v_exp_f32 v193, v193
    v_exp_f32 v194, v194
    v_exp_f32 v195, v195
    v_exp_f32 v196, v196
    v_exp_f32 v197, v197
    v_exp_f32 v198, v198
    v_exp_f32 v199, v199
    v_exp_f32 v200, v200
    v_exp_f32 v201, v201
    v_exp_f32 v202, v202
    v_exp_f32 v203, v203
    v_exp_f32 v204, v204
    v_exp_f32 v205, v205
    v_exp_f32 v206, v206
    v_exp_f32 v207, v207
    v_pk_add_f32 v[176:177], v[176:177], 1.0 op_sel_hi:[1,0]
    v_pk_add_f32 v[178:179], v[178:179], 1.0 op_sel_hi:[1,0]
    v_pk_add_f32 v[180:181], v[180:181], 1.0 op_sel_hi:[1,0]
    v_pk_add_f32 v[182:183], v[182:183], 1.0 op_sel_hi:[1,0]
    v_pk_add_f32 v[184:185], v[184:185], 1.0 op_sel_hi:[1,0]
    v_pk_add_f32 v[186:187], v[186:187], 1.0 op_sel_hi:[1,0]
    v_pk_add_f32 v[188:189], v[188:189], 1.0 op_sel_hi:[1,0]
    v_pk_add_f32 v[190:191], v[190:191], 1.0 op_sel_hi:[1,0]
    v_pk_add_f32 v[192:193], v[192:193], 1.0 op_sel_hi:[1,0]
    v_pk_add_f32 v[194:195], v[194:195], 1.0 op_sel_hi:[1,0]
    v_pk_add_f32 v[196:197], v[196:197], 1.0 op_sel_hi:[1,0]
    v_pk_add_f32 v[198:199], v[198:199], 1.0 op_sel_hi:[1,0]
    v_pk_add_f32 v[200:201], v[200:201], 1.0 op_sel_hi:[1,0]
    v_pk_add_f32 v[202:203], v[202:203], 1.0 op_sel_hi:[1,0]
    v_pk_add_f32 v[204:205], v[204:205], 1.0 op_sel_hi:[1,0]
    v_pk_add_f32 v[206:207], v[206:207], 1.0 op_sel_hi:[1,0]
    v_rcp_f32 v176, v176
    v_rcp_f32 v177, v177
    v_rcp_f32 v178, v178
    v_rcp_f32 v179, v179
    v_rcp_f32 v180, v180
    v_rcp_f32 v181, v181
    v_rcp_f32 v182, v182
    v_rcp_f32 v183, v183
    v_rcp_f32 v184, v184
    v_rcp_f32 v185, v185
    v_rcp_f32 v186, v186
    v_rcp_f32 v187, v187
    v_rcp_f32 v188, v188
    v_rcp_f32 v189, v189
    v_rcp_f32 v190, v190
    v_rcp_f32 v191, v191
    v_rcp_f32 v192, v192
    v_rcp_f32 v193, v193
    v_rcp_f32 v194, v194
    v_rcp_f32 v195, v195
    v_rcp_f32 v196, v196
    v_rcp_f32 v197, v197
    v_rcp_f32 v198, v198
    v_rcp_f32 v199, v199
    v_rcp_f32 v200, v200
    v_rcp_f32 v201, v201
    v_rcp_f32 v202, v202
    v_rcp_f32 v203, v203
    v_rcp_f32 v204, v204
    v_rcp_f32 v205, v205
    v_rcp_f32 v206, v206
    v_rcp_f32 v207, v207
    v_pk_mul_f32 v[176:177], v[176:177], v[24:25]
    v_pk_mul_f32 v[178:179], v[178:179], v[26:27]
    v_pk_mul_f32 v[180:181], v[180:181], v[28:29]
    v_pk_mul_f32 v[182:183], v[182:183], v[30:31]
    v_pk_mul_f32 v[184:185], v[184:185], v[52:53]
    v_pk_mul_f32 v[186:187], v[186:187], v[54:55]
    v_pk_mul_f32 v[188:189], v[188:189], v[56:57]
    v_pk_mul_f32 v[190:191], v[190:191], v[58:59]
    v_pk_mul_f32 v[192:193], v[192:193], v[80:81]
    v_pk_mul_f32 v[194:195], v[194:195], v[82:83]
    v_pk_mul_f32 v[196:197], v[196:197], v[84:85]
    v_pk_mul_f32 v[198:199], v[198:199], v[86:87]
    v_pk_mul_f32 v[200:201], v[200:201], v[108:109]
    v_pk_mul_f32 v[202:203], v[202:203], v[110:111]
    v_pk_mul_f32 v[204:205], v[204:205], v[112:113]
    v_pk_mul_f32 v[206:207], v[206:207], v[114:115]
    v_cvt_pk_bf16_f32 v24, v176, v177
    v_cvt_pk_bf16_f32 v25, v178, v179
    v_cvt_pk_bf16_f32 v26, v180, v181
    v_cvt_pk_bf16_f32 v27, v182, v183
    buffer_store_dwordx4 v[24:27], v2, s[16:19], s56 offen offset:0 sc1
    v_cvt_pk_bf16_f32 v52, v184, v185
    v_cvt_pk_bf16_f32 v53, v186, v187
    v_cvt_pk_bf16_f32 v54, v188, v189
    v_cvt_pk_bf16_f32 v55, v190, v191
    buffer_store_dwordx4 v[52:55], v2, s[16:19], s56 offen offset:2048 sc1
    v_cvt_pk_bf16_f32 v80, v192, v193
    v_cvt_pk_bf16_f32 v81, v194, v195
    v_cvt_pk_bf16_f32 v82, v196, v197
    v_cvt_pk_bf16_f32 v83, v198, v199
    buffer_store_dwordx4 v[80:83], v7, s[16:19], s56 offen offset:0 sc1
    v_cvt_pk_bf16_f32 v108, v200, v201
    v_cvt_pk_bf16_f32 v109, v202, v203
    v_cvt_pk_bf16_f32 v110, v204, v205
    v_cvt_pk_bf16_f32 v111, v206, v207
    buffer_store_dwordx4 v[108:111], v7, s[16:19], s56 offen offset:2048 sc1
    v_pk_fma_f32 v[32:33], v[144:145], v[208:209], v[32:33] op_sel_hi:[1,0,1]
    v_pk_fma_f32 v[34:35], v[146:147], v[208:209], v[34:35] op_sel_hi:[1,0,1]
    v_pk_fma_f32 v[60:61], v[144:145], v[216:217], v[60:61] op_sel_hi:[1,0,1]
    v_pk_fma_f32 v[62:63], v[146:147], v[216:217], v[62:63] op_sel_hi:[1,0,1]
    v_pk_fma_f32 v[88:89], v[144:145], v[224:225], v[88:89] op_sel_hi:[1,0,1]
    v_pk_fma_f32 v[90:91], v[146:147], v[224:225], v[90:91] op_sel_hi:[1,0,1]
    v_pk_fma_f32 v[116:117], v[144:145], v[232:233], v[116:117] op_sel_hi:[1,0,1]
    v_pk_fma_f32 v[118:119], v[146:147], v[232:233], v[118:119] op_sel_hi:[1,0,1]
    v_pk_fma_f32 v[32:33], v[32:33], v[210:211], v[172:173] op_sel_hi:[1,0,1]
    v_pk_fma_f32 v[34:35], v[34:35], v[210:211], v[174:175] op_sel_hi:[1,0,1]
    v_pk_fma_f32 v[60:61], v[60:61], v[218:219], v[172:173] op_sel_hi:[1,0,1]
    v_pk_fma_f32 v[62:63], v[62:63], v[218:219], v[174:175] op_sel_hi:[1,0,1]
    v_pk_fma_f32 v[88:89], v[88:89], v[226:227], v[172:173] op_sel_hi:[1,0,1]
    v_pk_fma_f32 v[90:91], v[90:91], v[226:227], v[174:175] op_sel_hi:[1,0,1]
    v_pk_fma_f32 v[116:117], v[116:117], v[234:235], v[172:173] op_sel_hi:[1,0,1]
    v_pk_fma_f32 v[118:119], v[118:119], v[234:235], v[174:175] op_sel_hi:[1,0,1]
    v_pk_mul_f32 v[176:177], v[32:33], v[32:33]
    v_pk_mul_f32 v[178:179], v[34:35], v[34:35]
    v_pk_mul_f32 v[180:181], v[60:61], v[60:61]
    v_pk_mul_f32 v[182:183], v[62:63], v[62:63]
    v_pk_mul_f32 v[184:185], v[88:89], v[88:89]
    v_pk_mul_f32 v[186:187], v[90:91], v[90:91]
    v_pk_mul_f32 v[188:189], v[116:117], v[116:117]
    v_pk_mul_f32 v[190:191], v[118:119], v[118:119]
    v_pk_fma_f32 v[176:177], v[176:177], s[52:53], v[4:5]
    v_pk_fma_f32 v[178:179], v[178:179], s[52:53], v[4:5]
    v_pk_fma_f32 v[180:181], v[180:181], s[52:53], v[4:5]
    v_pk_fma_f32 v[182:183], v[182:183], s[52:53], v[4:5]
    v_pk_fma_f32 v[184:185], v[184:185], s[52:53], v[4:5]
    v_pk_fma_f32 v[186:187], v[186:187], s[52:53], v[4:5]
    v_pk_fma_f32 v[188:189], v[188:189], s[52:53], v[4:5]
    v_pk_fma_f32 v[190:191], v[190:191], s[52:53], v[4:5]
    v_pk_mul_f32 v[176:177], v[176:177], v[32:33]
    v_pk_mul_f32 v[178:179], v[178:179], v[34:35]
    v_pk_mul_f32 v[180:181], v[180:181], v[60:61]
    v_pk_mul_f32 v[182:183], v[182:183], v[62:63]
    v_pk_mul_f32 v[184:185], v[184:185], v[88:89]
    v_pk_mul_f32 v[186:187], v[186:187], v[90:91]
    v_pk_mul_f32 v[188:189], v[188:189], v[116:117]
    v_pk_mul_f32 v[190:191], v[190:191], v[118:119]
    v_exp_f32 v176, v176
    v_exp_f32 v177, v177
    v_exp_f32 v178, v178
    v_exp_f32 v179, v179
    v_exp_f32 v180, v180
    v_exp_f32 v181, v181
    v_exp_f32 v182, v182
    v_exp_f32 v183, v183
    v_exp_f32 v184, v184
    v_exp_f32 v185, v185
    v_exp_f32 v186, v186
    v_exp_f32 v187, v187
    v_exp_f32 v188, v188
    v_exp_f32 v189, v189
    v_exp_f32 v190, v190
    v_exp_f32 v191, v191
    v_pk_add_f32 v[176:177], v[176:177], 1.0 op_sel_hi:[1,0]
    v_pk_add_f32 v[178:179], v[178:179], 1.0 op_sel_hi:[1,0]
    v_pk_add_f32 v[180:181], v[180:181], 1.0 op_sel_hi:[1,0]
    v_pk_add_f32 v[182:183], v[182:183], 1.0 op_sel_hi:[1,0]
    v_pk_add_f32 v[184:185], v[184:185], 1.0 op_sel_hi:[1,0]
    v_pk_add_f32 v[186:187], v[186:187], 1.0 op_sel_hi:[1,0]
    v_pk_add_f32 v[188:189], v[188:189], 1.0 op_sel_hi:[1,0]
    v_pk_add_f32 v[190:191], v[190:191], 1.0 op_sel_hi:[1,0]
    v_rcp_f32 v176, v176
    v_rcp_f32 v177, v177
    v_rcp_f32 v178, v178
    v_rcp_f32 v179, v179
    v_rcp_f32 v180, v180
    v_rcp_f32 v181, v181
    v_rcp_f32 v182, v182
    v_rcp_f32 v183, v183
    v_rcp_f32 v184, v184
    v_rcp_f32 v185, v185
    v_rcp_f32 v186, v186
    v_rcp_f32 v187, v187
    v_rcp_f32 v188, v188
    v_rcp_f32 v189, v189
    v_rcp_f32 v190, v190
    v_rcp_f32 v191, v191
    v_pk_mul_f32 v[176:177], v[176:177], v[32:33]
    v_pk_mul_f32 v[178:179], v[178:179], v[34:35]
    v_pk_mul_f32 v[180:181], v[180:181], v[60:61]
    v_pk_mul_f32 v[182:183], v[182:183], v[62:63]
    v_pk_mul_f32 v[184:185], v[184:185], v[88:89]
    v_pk_mul_f32 v[186:187], v[186:187], v[90:91]
    v_pk_mul_f32 v[188:189], v[188:189], v[116:117]
    v_pk_mul_f32 v[190:191], v[190:191], v[118:119]
    v_cvt_pk_bf16_f32 v32, v176, v177
    v_cvt_pk_bf16_f32 v33, v178, v179
    v_cvt_pk_bf16_f32 v34, v180, v181
    v_cvt_pk_bf16_f32 v35, v182, v183
    v_cvt_pk_bf16_f32 v88, v184, v185
    v_cvt_pk_bf16_f32 v89, v186, v187
    v_cvt_pk_bf16_f32 v90, v188, v189
    v_cvt_pk_bf16_f32 v91, v190, v191
    s_nop 1
    v_permlane16_swap_b32 v32, v34
    v_permlane16_swap_b32 v33, v35
    buffer_store_dwordx4 v[32:35], v6, s[16:19], s57 offen sc1
    s_add_u32 s57, s57, 4096
    v_permlane16_swap_b32 v88, v90
    v_permlane16_swap_b32 v89, v91
    buffer_store_dwordx4 v[88:91], v6, s[16:19], s57 offen sc1
    s_add_u32 s57, s57, 4096
    s_add_u32 s88, s4, 0x4400000
    s_addc_u32 s89, s5, 0
    s_mov_b32 s90, 0xe1400
    s_mov_b32 s91, 0x20000
    v_lshlrev_b32 v240, 7, v0
    v_mov_b32 v241, 1
    s_waitcnt vmcnt(0)
    s_mov_b64 exec, 1
    buffer_store_dword v241, v240, s[88:91], s92 offen sc1
    s_mov_b64 exec, -1
ffn1_end:
    s_mov_b32 s30, s29
    s_load_dwordx2 s[48:49], s[0:1], 56
    s_load_dwordx2 s[50:51], s[0:1], 64
    s_and_b32 s37, s2, 7
    s_lshr_b32 s38, s2, 3
    s_and_b32 s31, s37, 3
    s_lshl_b32 s31, s31, 2
    s_and_b32 s3, s38, 3
    s_add_u32 s31, s31, s3
    s_lshr_b32 s32, s37, 2
    s_lshl_b32 s32, s32, 3
    s_lshr_b32 s3, s38, 2
    s_add_u32 s32, s32, s3
    s_lshr_b32 s93, s32, 3
    s_and_b32 s32, s32, 7
    v_lshlrev_b32 v2, 4, v0
    s_cmp_lt_u32 s30, 4
    s_cbranch_scc1 ffn2_cons
    s_sub_u32 s30, s30, 4
    s_lshl_b32 s41, s30, 12
    s_mul_i32 s42, s30, 4096
    s_mul_i32 s35, s31, 917504
    s_add_u32 s35, s35, s41
    s_mul_i32 s36, s32, 917504
    s_add_u32 s36, s36, s42
    s_add_u32 s42, s42, 16384
    s_mov_b32 s33, 0
    s_waitcnt lgkmcnt(0)
    s_add_u32 s8, s4, 0x1800000
    s_addc_u32 s9, s5, 0
    s_mov_b32 s10, 0xe00000
    s_mov_b32 s11, 0x20000
    s_add_u32 s12, s4, 0x3c00000
    s_addc_u32 s13, s5, 0
    s_mov_b32 s14, 0xe00000
    s_mov_b32 s15, 0x20000
    s_mul_i32 s3, s93, 458752
    s_add_u32 s35, s35, s3
    s_lshl_b32 s36, s32, 1
    s_lshr_b32 s3, s30, 1
    s_add_u32 s36, s36, s3
    s_mul_i32 s36, s36, 458752
    s_and_b32 s3, s30, 1
    s_lshl_b32 s3, s3, 12
    s_add_u32 s36, s36, s3
    s_mul_i32 s3, s93, 229376
    s_add_u32 s36, s36, s3
    s_mov_b32 s14, 7340032
    s_add_u32 s88, s4, 0x4400000
    s_addc_u32 s89, s5, 0
    s_mov_b32 s90, 0xe1400
    s_mov_b32 s91, 0x20000
    s_mov_b32 s34, 3
ffn2_lpw:
    s_add_u32 m0, s33, s42
    s_add_u32 s38, s36, 4096
    buffer_load_dwordx4 v2, s[12:15], s36 offen offset:0 sc1 lds
    buffer_load_dwordx4 v2, s[12:15], s36 offen offset:1024 sc1 lds
    buffer_load_dwordx4 v2, s[12:15], s36 offen offset:2048 sc1 lds
    buffer_load_dwordx4 v2, s[12:15], s36 offen offset:3072 sc1 lds
    s_add_u32 s36, s36, 8192
    s_add_u32 s33, s33, 32768
    s_cmp_ge_u32 s33, 131072
    s_cselect_b32 s33, 0, s33
    s_sub_u32 s34, s34, 1
    s_cmp_lg_u32 s34, 0
    s_cbranch_scc1 ffn2_lpw
    s_lshl_b32 s43, s31, 2
    s_add_u32 s43, s43, s30
    s_lshr_b32 s43, s43, 1
    s_mul_i32 s43, s43, 4096
    s_add_u32 s43, s43, 524288
    s_mov_b32 s33, 0
    s_barrier
    s_lshl_b32 s3, s93, 11
    s_add_u32 s43, s43, s3
    s_add_u32 s45, s43, 0
    v_min_u32 v244, 15, v0
    v_lshlrev_b32 v244, 7, v244
    s_mov_b32 s87, 0x40000
    s_mov_b32 s86, 0x1
ffn2_plx:
    buffer_load_dword v240, v244, s[88:91], s45 offen sc1
    s_waitcnt vmcnt(0)
    v_cmp_ne_u32 vcc, s86, v240
    s_sub_u32 s87, s87, 1
    s_nop 3
    s_cbranch_vccz ffn2_pdx
    s_sleep 6
    s_cmp_lg_u32 s87, 0
    s_cbranch_scc1 ffn2_plx
ffn2_pdx:
    s_mov_b32 s34, 3
ffn2_lpx:
    s_add_u32 m0, s33, s41
    s_nop 0
    buffer_load_dwordx4 v2, s[8:11], s35 offen offset:0 sc1 lds
    buffer_load_dwordx4 v2, s[8:11], s35 offen offset:1024 sc1 lds
    buffer_load_dwordx4 v2, s[8:11], s35 offen offset:2048 sc1 lds
    buffer_load_dwordx4 v2, s[8:11], s35 offen offset:3072 sc1 lds
    s_add_u32 s35, s35, 16384
    s_add_u32 s33, s33, 32768
    s_cmp_ge_u32 s33, 131072
    s_cselect_b32 s33, 0, s33
    s_sub_u32 s34, s34, 1
    s_cmp_lg_u32 s34, 0
    s_cbranch_scc1 ffn2_lpx
    s_waitcnt vmcnt(8)
    s_barrier
    s_add_u32 m0, s33, s42
    s_add_u32 s38, s36, 4096
    buffer_load_dwordx4 v2, s[12:15], s36 offen offset:0 sc1 lds
    buffer_load_dwordx4 v2, s[12:15], s36 offen offset:1024 sc1 lds
    buffer_load_dwordx4 v2, s[12:15], s36 offen offset:2048 sc1 lds
    buffer_load_dwordx4 v2, s[12:15], s36 offen offset:3072 sc1 lds
    s_add_u32 s36, s36, 8192
    s_add_u32 m0, s33, s41
    s_nop 0
    buffer_load_dwordx4 v2, s[8:11], s35 offen offset:0 sc1 lds
    buffer_load_dwordx4 v2, s[8:11], s35 offen offset:1024 sc1 lds
    buffer_load_dwordx4 v2, s[8:11], s35 offen offset:2048 sc1 lds
    buffer_load_dwordx4 v2, s[8:11], s35 offen offset:3072 sc1 lds
    s_add_u32 s35, s35, 16384
    s_add_u32 s33, s33, 32768
    s_cmp_ge_u32 s33, 131072
    s_cselect_b32 s33, 0, s33
    s_waitcnt vmcnt(12)
    s_barrier
    s_add_u32 m0, s33, s42
    s_add_u32 s38, s36, 4096
    buffer_load_dwordx4 v2, s[12:15], s36 offen offset:0 sc1 lds
    buffer_load_dwordx4 v2, s[12:15], s36 offen offset:1024 sc1 lds
    buffer_load_dwordx4 v2, s[12:15], s36 offen offset:2048 sc1 lds
    buffer_load_dwordx4 v2, s[12:15], s36 offen offset:3072 sc1 lds
    s_add_u32 s36, s36, 8192
    s_add_u32 m0, s33, s41
    s_nop 0
    buffer_load_dwordx4 v2, s[8:11], s35 offen offset:0 sc1 lds
    buffer_load_dwordx4 v2, s[8:11], s35 offen offset:1024 sc1 lds
    buffer_load_dwordx4 v2, s[8:11], s35 offen offset:2048 sc1 lds
    buffer_load_dwordx4 v2, s[8:11], s35 offen offset:3072 sc1 lds
    s_add_u32 s35, s35, 16384
    s_add_u32 s33, s33, 32768
    s_cmp_ge_u32 s33, 131072
    s_cselect_b32 s33, 0, s33
    s_waitcnt vmcnt(16)
    s_barrier
    s_add_u32 m0, s33, s42
    s_add_u32 s38, s36, 4096
    buffer_load_dwordx4 v2, s[12:15], s36 offen offset:0 sc1 lds
    buffer_load_dwordx4 v2, s[12:15], s36 offen offset:1024 sc1 lds
    buffer_load_dwordx4 v2, s[12:15], s36 offen offset:2048 sc1 lds
    buffer_load_dwordx4 v2, s[12:15], s36 offen offset:3072 sc1 lds
    s_add_u32 s36, s36, 8192
    s_add_u32 m0, s33, s41
    s_nop 0
    buffer_load_dwordx4 v2, s[8:11], s35 offen offset:0 sc1 lds
    buffer_load_dwordx4 v2, s[8:11], s35 offen offset:1024 sc1 lds
    buffer_load_dwordx4 v2, s[8:11], s35 offen offset:2048 sc1 lds
    buffer_load_dwordx4 v2, s[8:11], s35 offen offset:3072 sc1 lds
    s_add_u32 s35, s35, 16384
    s_add_u32 s33, s33, 32768
    s_cmp_ge_u32 s33, 131072
    s_cselect_b32 s33, 0, s33
    s_mov_b32 s34, 22
ffn2_lloop:
    s_waitcnt vmcnt(16)
    s_barrier
    s_add_u32 m0, s33, s42
    s_add_u32 s38, s36, 4096
    buffer_load_dwordx4 v2, s[12:15], s36 offen offset:0 sc1 lds
    buffer_load_dwordx4 v2, s[12:15], s36 offen offset:1024 sc1 lds
    buffer_load_dwordx4 v2, s[12:15], s36 offen offset:2048 sc1 lds
    buffer_load_dwordx4 v2, s[12:15], s36 offen offset:3072 sc1 lds
    s_add_u32 s36, s36, 8192
    s_add_u32 m0, s33, s41
    s_nop 0
    buffer_load_dwordx4 v2, s[8:11], s35 offen offset:0 sc1 lds
    buffer_load_dwordx4 v2, s[8:11], s35 offen offset:1024 sc1 lds
    buffer_load_dwordx4 v2, s[8:11], s35 offen offset:2048 sc1 lds
    buffer_load_dwordx4 v2, s[8:11], s35 offen offset:3072 sc1 lds
    s_add_u32 s35, s35, 16384
    s_add_u32 s33, s33, 32768
    s_cmp_ge_u32 s33, 131072
    s_cselect_b32 s33, 0, s33
    s_sub_u32 s34, s34, 1
    s_cmp_lg_u32 s34, 0
    s_cbranch_scc1 ffn2_lloop
    s_waitcnt vmcnt(16)
    s_barrier
    s_waitcnt vmcnt(8)
    s_barrier
    s_waitcnt vmcnt(0)
    s_barrier
    s_barrier
    s_endpgm
ffn2_cons:
    s_lshr_b32 s39, s30, 1
    s_and_b32 s40, s30, 1
    s_mul_i32 s37, s39, 8192
    v_add_u32 v4, s37, v2
    s_mul_i32 s37, s40, 8192
    s_add_u32 s37, s37, 16384
    v_add_u32 v5, s37, v2
    v_mov_b32 v6, v4
    v_mov_b32 v3, v5
    s_mov_b32 s33, 0
    s_mov_b32 s34, 28
    s_waitcnt lgkmcnt(0)
    s_lshl_b32 s94, s31, 3
    s_add_u32 s94, s94, s32
    s_lshl_b32 s94, s94, 2
    s_add_u32 s94, s94, s30
    s_lshl_b32 s94, s94, 1
    s_add_u32 s94, s94, s93
    s_lshl_b32 s39, s39, 1
    s_add_u32 s39, s39, s93
    s_lshl_b32 s32, s32, 1
    s_add_u32 s32, s32, s40
    s_barrier
    v_mov_b32 v8, 0
    v_mov_b32 v9, 0
    v_mov_b32 v10, 0
    v_mov_b32 v11, 0
    v_mov_b32 v12, 0
    v_mov_b32 v13, 0
    v_mov_b32 v14, 0
    v_mov_b32 v15, 0
    v_mov_b32 v16, 0
    v_mov_b32 v17, 0
    v_mov_b32 v18, 0
    v_mov_b32 v19, 0
    v_mov_b32 v20, 0
    v_mov_b32 v21, 0
    v_mov_b32 v22, 0
    v_mov_b32 v23, 0
    v_mov_b32 v24, 0
    v_mov_b32 v25, 0
    v_mov_b32 v26, 0
    v_mov_b32 v27, 0
    v_mov_b32 v28, 0
    v_mov_b32 v29, 0
    v_mov_b32 v30, 0
    v_mov_b32 v31, 0
    v_mov_b32 v32, 0
    v_mov_b32 v33, 0
    v_mov_b32 v34, 0
    v_mov_b32 v35, 0
    v_mov_b32 v36, 0
    v_mov_b32 v37, 0
    v_mov_b32 v38, 0
    v_mov_b32 v39, 0
    v_mov_b32 v40, 0
    v_mov_b32 v41, 0
    v_mov_b32 v42, 0
    v_mov_b32 v43, 0
    v_mov_b32 v44, 0
    v_mov_b32 v45, 0
    v_mov_b32 v46, 0
    v_mov_b32 v47, 0
    v_mov_b32 v48, 0
    v_mov_b32 v49, 0
    v_mov_b32 v50, 0
    v_mov_b32 v51, 0
    v_mov_b32 v52, 0
    v_mov_b32 v53, 0
    v_mov_b32 v54, 0
    v_mov_b32 v55, 0
    v_mov_b32 v56, 0
    v_mov_b32 v57, 0
    v_mov_b32 v58, 0
    v_mov_b32 v59, 0
    v_mov_b32 v60, 0
    v_mov_b32 v61, 0
    v_mov_b32 v62, 0
    v_mov_b32 v63, 0
    v_mov_b32 v64, 0
    v_mov_b32 v65, 0
    v_mov_b32 v66, 0
    v_mov_b32 v67, 0
    v_mov_b32 v68, 0
    v_mov_b32 v69, 0
    v_mov_b32 v70, 0
    v_mov_b32 v71, 0
    s_barrier
    ds_read_b128 v[88:91], v3 offset:0
    ds_read_b128 v[72:75], v6 offset:0
    ds_read_b128 v[76:79], v6 offset:2048
    ds_read_b128 v[80:83], v6 offset:4096
    ds_read_b128 v[84:87], v6 offset:6144
    ds_read_b128 v[92:95], v3 offset:2048
    ds_read_b128 v[96:99], v3 offset:4096
    ds_read_b128 v[100:103], v3 offset:6144
.p2align 3
ffn2_cloop:
    s_cmp_eq_u32 s34, 2
    s_cbranch_scc1 ffn2_aux
ffn2_auxd:
    s_waitcnt lgkmcnt(6)
    v_mfma_f32_16x16x32_bf16 v[8:11], v[88:91], v[72:75], v[8:11]
    ds_read_b128 v[120:123], v3 offset:1024
    s_waitcnt lgkmcnt(6)
    v_mfma_f32_16x16x32_bf16 v[24:27], v[88:91], v[76:79], v[24:27]
    ds_read_b128 v[104:107], v6 offset:1024
    s_waitcnt lgkmcnt(6)
    v_mfma_f32_16x16x32_bf16 v[40:43], v[88:91], v[80:83], v[40:43]
    ds_read_b128 v[108:111], v6 offset:3072
    s_waitcnt lgkmcnt(6)
    v_mfma_f32_16x16x32_bf16 v[56:59], v[88:91], v[84:87], v[56:59]
    ds_read_b128 v[112:115], v6 offset:5120
    s_waitcnt lgkmcnt(6)
    v_mfma_f32_16x16x32_bf16 v[12:15], v[92:95], v[72:75], v[12:15]
    ds_read_b128 v[116:119], v6 offset:7168
    v_mfma_f32_16x16x32_bf16 v[28:31], v[92:95], v[76:79], v[28:31]
    ds_read_b128 v[124:127], v3 offset:3072
    v_mfma_f32_16x16x32_bf16 v[44:47], v[92:95], v[80:83], v[44:47]
    ds_read_b128 v[128:131], v3 offset:5120
    v_mfma_f32_16x16x32_bf16 v[60:63], v[92:95], v[84:87], v[60:63]
    ds_read_b128 v[132:135], v3 offset:7168
    s_waitcnt lgkmcnt(9)
    v_mfma_f32_16x16x32_bf16 v[16:19], v[96:99], v[72:75], v[16:19]
    v_mfma_f32_16x16x32_bf16 v[32:35], v[96:99], v[76:79], v[32:35]
    v_mfma_f32_16x16x32_bf16 v[48:51], v[96:99], v[80:83], v[48:51]
    v_mfma_f32_16x16x32_bf16 v[64:67], v[96:99], v[84:87], v[64:67]
    s_waitcnt lgkmcnt(8)
    v_mfma_f32_16x16x32_bf16 v[20:23], v[100:103], v[72:75], v[20:23]
    v_mfma_f32_16x16x32_bf16 v[36:39], v[100:103], v[76:79], v[36:39]
    v_mfma_f32_16x16x32_bf16 v[52:55], v[100:103], v[80:83], v[52:55]
    v_mfma_f32_16x16x32_bf16 v[68:71], v[100:103], v[84:87], v[68:71]
    s_waitcnt lgkmcnt(6)
    v_mfma_f32_16x16x32_bf16 v[8:11], v[120:123], v[104:107], v[8:11]
    s_add_u32 s33, s33, 32768
    s_cmp_ge_u32 s33, 131072
    s_cselect_b32 s33, 0, s33
    s_waitcnt lgkmcnt(5)
    v_mfma_f32_16x16x32_bf16 v[24:27], v[120:123], v[108:111], v[24:27]
    s_waitcnt lgkmcnt(4)
    v_mfma_f32_16x16x32_bf16 v[40:43], v[120:123], v[112:115], v[40:43]
    s_waitcnt lgkmcnt(0)
    v_add_u32 v6, s33, v4
    v_add_u32 v3, s33, v5
    s_barrier
    ds_read_b128 v[88:91], v3 offset:0
    v_mfma_f32_16x16x32_bf16 v[56:59], v[120:123], v[116:119], v[56:59]
    ds_read_b128 v[72:75], v6 offset:0
    v_mfma_f32_16x16x32_bf16 v[12:15], v[124:127], v[104:107], v[12:15]
    ds_read_b128 v[76:79], v6 offset:2048
    v_mfma_f32_16x16x32_bf16 v[28:31], v[124:127], v[108:111], v[28:31]
    ds_read_b128 v[80:83], v6 offset:4096
    v_mfma_f32_16x16x32_bf16 v[44:47], v[124:127], v[112:115], v[44:47]
    ds_read_b128 v[84:87], v6 offset:6144
    v_mfma_f32_16x16x32_bf16 v[60:63], v[124:127], v[116:119], v[60:63]
    ds_read_b128 v[92:95], v3 offset:2048
    v_mfma_f32_16x16x32_bf16 v[16:19], v[128:131], v[104:107], v[16:19]
    ds_read_b128 v[96:99], v3 offset:4096
    v_mfma_f32_16x16x32_bf16 v[32:35], v[128:131], v[108:111], v[32:35]
    ds_read_b128 v[100:103], v3 offset:6144
    v_mfma_f32_16x16x32_bf16 v[48:51], v[128:131], v[112:115], v[48:51]
    v_mfma_f32_16x16x32_bf16 v[64:67], v[128:131], v[116:119], v[64:67]
    v_mfma_f32_16x16x32_bf16 v[20:23], v[132:135], v[104:107], v[20:23]
    v_mfma_f32_16x16x32_bf16 v[36:39], v[132:135], v[108:111], v[36:39]
    v_mfma_f32_16x16x32_bf16 v[52:55], v[132:135], v[112:115], v[52:55]
    v_mfma_f32_16x16x32_bf16 v[68:71], v[132:135], v[116:119], v[68:71]
    s_waitcnt lgkmcnt(6)
    v_mfma_f32_16x16x32_bf16 v[8:11], v[88:91], v[72:75], v[8:11]
    ds_read_b128 v[120:123], v3 offset:1024
    s_waitcnt lgkmcnt(6)
    v_mfma_f32_16x16x32_bf16 v[24:27], v[88:91], v[76:79], v[24:27]
    ds_read_b128 v[104:107], v6 offset:1024
    s_waitcnt lgkmcnt(6)
    v_mfma_f32_16x16x32_bf16 v[40:43], v[88:91], v[80:83], v[40:43]
    ds_read_b128 v[108:111], v6 offset:3072
    s_waitcnt lgkmcnt(6)
    v_mfma_f32_16x16x32_bf16 v[56:59], v[88:91], v[84:87], v[56:59]
    ds_read_b128 v[112:115], v6 offset:5120
    s_waitcnt lgkmcnt(6)
    v_mfma_f32_16x16x32_bf16 v[12:15], v[92:95], v[72:75], v[12:15]
    ds_read_b128 v[116:119], v6 offset:7168
    v_mfma_f32_16x16x32_bf16 v[28:31], v[92:95], v[76:79], v[28:31]
    ds_read_b128 v[124:127], v3 offset:3072
    v_mfma_f32_16x16x32_bf16 v[44:47], v[92:95], v[80:83], v[44:47]
    ds_read_b128 v[128:131], v3 offset:5120
    v_mfma_f32_16x16x32_bf16 v[60:63], v[92:95], v[84:87], v[60:63]
    ds_read_b128 v[132:135], v3 offset:7168
    s_waitcnt lgkmcnt(9)
    v_mfma_f32_16x16x32_bf16 v[16:19], v[96:99], v[72:75], v[16:19]
    v_mfma_f32_16x16x32_bf16 v[32:35], v[96:99], v[76:79], v[32:35]
    v_mfma_f32_16x16x32_bf16 v[48:51], v[96:99], v[80:83], v[48:51]
    v_mfma_f32_16x16x32_bf16 v[64:67], v[96:99], v[84:87], v[64:67]
    s_waitcnt lgkmcnt(8)
    v_mfma_f32_16x16x32_bf16 v[20:23], v[100:103], v[72:75], v[20:23]
    v_mfma_f32_16x16x32_bf16 v[36:39], v[100:103], v[76:79], v[36:39]
    v_mfma_f32_16x16x32_bf16 v[52:55], v[100:103], v[80:83], v[52:55]
    v_mfma_f32_16x16x32_bf16 v[68:71], v[100:103], v[84:87], v[68:71]
    s_waitcnt lgkmcnt(6)
    v_mfma_f32_16x16x32_bf16 v[8:11], v[120:123], v[104:107], v[8:11]
    s_add_u32 s33, s33, 32768
    s_cmp_ge_u32 s33, 131072
    s_cselect_b32 s33, 0, s33
    s_waitcnt lgkmcnt(5)
    v_mfma_f32_16x16x32_bf16 v[24:27], v[120:123], v[108:111], v[24:27]
    s_waitcnt lgkmcnt(4)
    v_mfma_f32_16x16x32_bf16 v[40:43], v[120:123], v[112:115], v[40:43]
    s_waitcnt lgkmcnt(0)
    v_add_u32 v6, s33, v4
    v_add_u32 v3, s33, v5
    s_barrier
    ds_read_b128 v[88:91], v3 offset:0
    v_mfma_f32_16x16x32_bf16 v[56:59], v[120:123], v[116:119], v[56:59]
    ds_read_b128 v[72:75], v6 offset:0
    v_mfma_f32_16x16x32_bf16 v[12:15], v[124:127], v[104:107], v[12:15]
    ds_read_b128 v[76:79], v6 offset:2048
    v_mfma_f32_16x16x32_bf16 v[28:31], v[124:127], v[108:111], v[28:31]
    ds_read_b128 v[80:83], v6 offset:4096
    v_mfma_f32_16x16x32_bf16 v[44:47], v[124:127], v[112:115], v[44:47]
    ds_read_b128 v[84:87], v6 offset:6144
    v_mfma_f32_16x16x32_bf16 v[60:63], v[124:127], v[116:119], v[60:63]
    ds_read_b128 v[92:95], v3 offset:2048
    v_mfma_f32_16x16x32_bf16 v[16:19], v[128:131], v[104:107], v[16:19]
    ds_read_b128 v[96:99], v3 offset:4096
    v_mfma_f32_16x16x32_bf16 v[32:35], v[128:131], v[108:111], v[32:35]
    ds_read_b128 v[100:103], v3 offset:6144
    v_mfma_f32_16x16x32_bf16 v[48:51], v[128:131], v[112:115], v[48:51]
    v_mfma_f32_16x16x32_bf16 v[64:67], v[128:131], v[116:119], v[64:67]
    v_mfma_f32_16x16x32_bf16 v[20:23], v[132:135], v[104:107], v[20:23]
    v_mfma_f32_16x16x32_bf16 v[36:39], v[132:135], v[108:111], v[36:39]
    v_mfma_f32_16x16x32_bf16 v[52:55], v[132:135], v[112:115], v[52:55]
    s_sub_u32 s34, s34, 2
    s_cmp_lg_u32 s34, 0
    v_mfma_f32_16x16x32_bf16 v[68:71], v[132:135], v[116:119], v[68:71]
    s_cbranch_scc1 ffn2_cloop
    s_waitcnt lgkmcnt(0)
    s_nop 7
    s_add_u32 s20, s4, 0x4500000
    s_addc_u32 s21, s5, 0
    s_mov_b32 s22, 0x800000
    s_mov_b32 s23, 0x20000
    s_lshl_b32 s44, s94, 13
    s_add_u32 s45, s44, 4096
    s_cmp_eq_u32 s93, 0
    s_cbranch_scc1 ffn2_nsw
    v_swap_b32 v8, v40
    v_swap_b32 v9, v41
    v_swap_b32 v10, v42
    v_swap_b32 v11, v43
    v_swap_b32 v12, v44
    v_swap_b32 v13, v45
    v_swap_b32 v14, v46
    v_swap_b32 v15, v47
    v_swap_b32 v16, v48
    v_swap_b32 v17, v49
    v_swap_b32 v18, v50
    v_swap_b32 v19, v51
    v_swap_b32 v20, v52
    v_swap_b32 v21, v53
    v_swap_b32 v22, v54
    v_swap_b32 v23, v55
    v_swap_b32 v24, v56
    v_swap_b32 v25, v57
    v_swap_b32 v26, v58
    v_swap_b32 v27, v59
    v_swap_b32 v28, v60
    v_swap_b32 v29, v61
    v_swap_b32 v30, v62
    v_swap_b32 v31, v63
    v_swap_b32 v32, v64
    v_swap_b32 v33, v65
    v_swap_b32 v34, v66
    v_swap_b32 v35, v67
    v_swap_b32 v36, v68
    v_swap_b32 v37, v69
    v_swap_b32 v38, v70
    v_swap_b32 v39, v71
ffn2_nsw:
    v_cvt_pk_bf16_f32 v88, v40, v41
    v_cvt_pk_bf16_f32 v89, v42, v43
    v_cvt_pk_bf16_f32 v90, v44, v45
    v_cvt_pk_bf16_f32 v91, v46, v47
    buffer_store_dwordx4 v[88:91], v2, s[20:23], s44 offen offset:0 sc1
    v_cvt_pk_bf16_f32 v92, v48, v49
    v_cvt_pk_bf16_f32 v93, v50, v51
    v_cvt_pk_bf16_f32 v94, v52, v53
    v_cvt_pk_bf16_f32 v95, v54, v55
    buffer_store_dwordx4 v[92:95], v2, s[20:23], s44 offen offset:1024 sc1
    v_cvt_pk_bf16_f32 v96, v56, v57
    v_cvt_pk_bf16_f32 v97, v58, v59
    v_cvt_pk_bf16_f32 v98, v60, v61
    v_cvt_pk_bf16_f32 v99, v62, v63
    buffer_store_dwordx4 v[96:99], v2, s[20:23], s44 offen offset:2048 sc1
    v_cvt_pk_bf16_f32 v100, v64, v65
    v_cvt_pk_bf16_f32 v101, v66, v67
    v_cvt_pk_bf16_f32 v102, v68, v69
    v_cvt_pk_bf16_f32 v103, v70, v71
    buffer_store_dwordx4 v[100:103], v2, s[20:23], s44 offen offset:3072 sc1
    s_waitcnt vmcnt(4)
    s_mov_b32 s16, s50
    s_mov_b32 s17, s51
    s_mov_b32 s18, 0x400000
    s_mov_b32 s19, 0x20000
    s_lshl_b32 s41, s31, 2
    s_add_u32 s41, s41, s39
    s_lshl_b32 s41, s41, 16
    s_lshl_b32 s3, s32, 7
    s_add_u32 s41, s41, s3
    s_add_u32 s42, s41, 32768
    v_and_b32 v7, 15, v0
    v_lshlrev_b32 v7, 11, v7
    v_lshrrev_b32 v1, 4, v0
    v_lshl_add_u32 v7, v1, 4, v7
    v_lshlrev_b32 v170, 16, v140
    v_and_b32 v171, 0xffff0000, v140
    v_lshlrev_b32 v172, 16, v141
    v_and_b32 v173, 0xffff0000, v141
    v_lshlrev_b32 v174, 16, v142
    v_and_b32 v175, 0xffff0000, v142
    v_lshlrev_b32 v176, 16, v143
    v_and_b32 v177, 0xffff0000, v143
    v_lshlrev_b32 v178, 16, v144
    v_and_b32 v179, 0xffff0000, v144
    v_lshlrev_b32 v180, 16, v145
    v_and_b32 v181, 0xffff0000, v145
    v_lshlrev_b32 v182, 16, v146
    v_and_b32 v183, 0xffff0000, v146
    v_lshlrev_b32 v184, 16, v147
    v_and_b32 v185, 0xffff0000, v147
    v_lshlrev_b32 v186, 16, v148
    v_and_b32 v187, 0xffff0000, v148
    v_lshlrev_b32 v188, 16, v149
    v_and_b32 v189, 0xffff0000, v149
    v_lshlrev_b32 v190, 16, v150
    v_and_b32 v191, 0xffff0000, v150
    v_lshlrev_b32 v192, 16, v151
    v_and_b32 v193, 0xffff0000, v151
    v_lshlrev_b32 v194, 16, v152
    v_and_b32 v195, 0xffff0000, v152
    v_lshlrev_b32 v196, 16, v153
    v_and_b32 v197, 0xffff0000, v153
    v_lshlrev_b32 v198, 16, v154
    v_and_b32 v199, 0xffff0000, v154
    v_lshlrev_b32 v200, 16, v155
    v_and_b32 v201, 0xffff0000, v155
    v_lshlrev_b32 v202, 16, v156
    v_and_b32 v203, 0xffff0000, v156
    v_lshlrev_b32 v204, 16, v157
    v_and_b32 v205, 0xffff0000, v157
    v_lshlrev_b32 v206, 16, v158
    v_and_b32 v207, 0xffff0000, v158
    v_lshlrev_b32 v208, 16, v159
    v_and_b32 v209, 0xffff0000, v159
    v_lshlrev_b32 v210, 16, v160
    v_and_b32 v211, 0xffff0000, v160
    v_lshlrev_b32 v212, 16, v161
    v_and_b32 v213, 0xffff0000, v161
    v_lshlrev_b32 v214, 16, v162
    v_and_b32 v215, 0xffff0000, v162
    v_lshlrev_b32 v216, 16, v163
    v_and_b32 v217, 0xffff0000, v163
    v_pk_add_f32 v[8:9], v[8:9], v[202:203]
    v_pk_add_f32 v[10:11], v[10:11], v[204:205]
    v_pk_add_f32 v[12:13], v[12:13], v[206:207]
    v_pk_add_f32 v[14:15], v[14:15], v[208:209]
    v_pk_add_f32 v[16:17], v[16:17], v[210:211]
    v_pk_add_f32 v[18:19], v[18:19], v[212:213]
    v_pk_add_f32 v[20:21], v[20:21], v[214:215]
    v_pk_add_f32 v[22:23], v[22:23], v[216:217]
    v_pk_add_f32 v[24:25], v[24:25], v[202:203]
    v_pk_add_f32 v[26:27], v[26:27], v[204:205]
    v_pk_add_f32 v[28:29], v[28:29], v[206:207]
    v_pk_add_f32 v[30:31], v[30:31], v[208:209]
    v_pk_add_f32 v[32:33], v[32:33], v[210:211]
    v_pk_add_f32 v[34:35], v[34:35], v[212:213]
    v_pk_add_f32 v[36:37], v[36:37], v[214:215]
    v_pk_add_f32 v[38:39], v[38:39], v[216:217]
    v_pk_add_f32 v[8:9], v[8:9], v[170:171]
    v_pk_add_f32 v[10:11], v[10:11], v[172:173]
    v_pk_add_f32 v[12:13], v[12:13], v[174:175]
    v_pk_add_f32 v[14:15], v[14:15], v[176:177]
    v_pk_add_f32 v[16:17], v[16:17], v[178:179]
    v_pk_add_f32 v[18:19], v[18:19], v[180:181]
    v_pk_add_f32 v[20:21], v[20:21], v[182:183]
    v_pk_add_f32 v[22:23], v[22:23], v[184:185]
    v_pk_add_f32 v[24:25], v[24:25], v[186:187]
    v_pk_add_f32 v[26:27], v[26:27], v[188:189]
    v_pk_add_f32 v[28:29], v[28:29], v[190:191]
    v_pk_add_f32 v[30:31], v[30:31], v[192:193]
    v_pk_add_f32 v[32:33], v[32:33], v[194:195]
    v_pk_add_f32 v[34:35], v[34:35], v[196:197]
    v_pk_add_f32 v[36:37], v[36:37], v[198:199]
    v_pk_add_f32 v[38:39], v[38:39], v[200:201]
    s_add_u32 s88, s4, 0x4400000
    s_addc_u32 s89, s5, 0
    s_mov_b32 s90, 0xe1400
    s_mov_b32 s91, 0x20000
    s_lshl_b32 s43, s94, 7
    s_add_u32 s43, s43, 660480
    v_lshlrev_b32 v240, 7, v0
    v_mov_b32 v241, 1
    s_waitcnt vmcnt(0)
    s_mov_b64 exec, 1
    buffer_store_dword v241, v240, s[88:91], s43 offen sc1
    s_mov_b64 exec, -1
    s_xor_b32 s94, s94, 1
    s_lshl_b32 s43, s94, 7
    s_add_u32 s43, s43, 660480
    s_lshl_b32 s44, s94, 13
    s_add_u32 s45, s44, 4096
    v_min_u32 v244, 0, v0
    v_lshlrev_b32 v244, 7, v244
    s_mov_b32 s87, 0x40000
    s_mov_b32 s86, 0x1
ffn2_ple:
    buffer_load_dword v240, v244, s[88:91], s43 offen sc1
    s_waitcnt vmcnt(0)
    v_cmp_ne_u32 vcc, s86, v240
    s_sub_u32 s87, s87, 1
    s_nop 3
    s_cbranch_vccz ffn2_pde
    s_sleep 1
    s_cmp_lg_u32 s87, 0
    s_cbranch_scc1 ffn2_ple
ffn2_pde:
    buffer_load_dwordx4 v[104:107], v2, s[20:23], s44 offen offset:0 sc1
    buffer_load_dwordx4 v[108:111], v2, s[20:23], s44 offen offset:1024 sc1
    buffer_load_dwordx4 v[112:115], v2, s[20:23], s44 offen offset:2048 sc1
    buffer_load_dwordx4 v[116:119], v2, s[20:23], s44 offen offset:3072 sc1
    s_waitcnt vmcnt(3)
    v_lshlrev_b32 v40, 16, v104
    v_and_b32 v41, 0xffff0000, v104
    v_lshlrev_b32 v42, 16, v105
    v_and_b32 v43, 0xffff0000, v105
    v_lshlrev_b32 v44, 16, v106
    v_and_b32 v45, 0xffff0000, v106
    v_lshlrev_b32 v46, 16, v107
    v_and_b32 v47, 0xffff0000, v107
    v_pk_add_f32 v[8:9], v[8:9], v[40:41]
    v_pk_add_f32 v[10:11], v[10:11], v[42:43]
    v_pk_add_f32 v[12:13], v[12:13], v[44:45]
    v_pk_add_f32 v[14:15], v[14:15], v[46:47]
    v_cvt_pk_bf16_f32 v72, v8, v9
    v_cvt_pk_bf16_f32 v73, v10, v11
    v_cvt_pk_bf16_f32 v74, v12, v13
    v_cvt_pk_bf16_f32 v75, v14, v15
    buffer_store_dwordx4 v[72:75], v7, s[16:19], s41 offen offset:0
    s_waitcnt vmcnt(3)
    v_lshlrev_b32 v48, 16, v108
    v_and_b32 v49, 0xffff0000, v108
    v_lshlrev_b32 v50, 16, v109
    v_and_b32 v51, 0xffff0000, v109
    v_lshlrev_b32 v52, 16, v110
    v_and_b32 v53, 0xffff0000, v110
    v_lshlrev_b32 v54, 16, v111
    v_and_b32 v55, 0xffff0000, v111
    v_pk_add_f32 v[16:17], v[16:17], v[48:49]
    v_pk_add_f32 v[18:19], v[18:19], v[50:51]
    v_pk_add_f32 v[20:21], v[20:21], v[52:53]
    v_pk_add_f32 v[22:23], v[22:23], v[54:55]
    v_cvt_pk_bf16_f32 v76, v16, v17
    v_cvt_pk_bf16_f32 v77, v18, v19
    v_cvt_pk_bf16_f32 v78, v20, v21
    v_cvt_pk_bf16_f32 v79, v22, v23
    buffer_store_dwordx4 v[76:79], v7, s[16:19], s41 offen offset:64
    s_waitcnt vmcnt(3)
    v_lshlrev_b32 v56, 16, v112
    v_and_b32 v57, 0xffff0000, v112
    v_lshlrev_b32 v58, 16, v113
    v_and_b32 v59, 0xffff0000, v113
    v_lshlrev_b32 v60, 16, v114
    v_and_b32 v61, 0xffff0000, v114
    v_lshlrev_b32 v62, 16, v115
    v_and_b32 v63, 0xffff0000, v115
    v_pk_add_f32 v[24:25], v[24:25], v[56:57]
    v_pk_add_f32 v[26:27], v[26:27], v[58:59]
    v_pk_add_f32 v[28:29], v[28:29], v[60:61]
    v_pk_add_f32 v[30:31], v[30:31], v[62:63]
    v_cvt_pk_bf16_f32 v80, v24, v25
    v_cvt_pk_bf16_f32 v81, v26, v27
    v_cvt_pk_bf16_f32 v82, v28, v29
    v_cvt_pk_bf16_f32 v83, v30, v31
    buffer_store_dwordx4 v[80:83], v7, s[16:19], s42 offen offset:0
    s_waitcnt vmcnt(3)
    v_lshlrev_b32 v64, 16, v116
    v_and_b32 v65, 0xffff0000, v116
    v_lshlrev_b32 v66, 16, v117
    v_and_b32 v67, 0xffff0000, v117
    v_lshlrev_b32 v68, 16, v118
    v_and_b32 v69, 0xffff0000, v118
    v_lshlrev_b32 v70, 16, v119
    v_and_b32 v71, 0xffff0000, v119
    v_pk_add_f32 v[32:33], v[32:33], v[64:65]
    v_pk_add_f32 v[34:35], v[34:35], v[66:67]
    v_pk_add_f32 v[36:37], v[36:37], v[68:69]
    v_pk_add_f32 v[38:39], v[38:39], v[70:71]
    v_cvt_pk_bf16_f32 v84, v32, v33
    v_cvt_pk_bf16_f32 v85, v34, v35
    v_cvt_pk_bf16_f32 v86, v36, v37
    v_cvt_pk_bf16_f32 v87, v38, v39
    buffer_store_dwordx4 v[84:87], v7, s[16:19], s42 offen offset:64
ffn2_end:
fused_kernel_exit:
    s_endpgm
qkv_aux:
    s_waitcnt vmcnt(0)
    s_cmp_eq_u32 s34, 12
    s_cbranch_scc0 qkv_auxd
    s_cmp_eq_u32 s30, 0
    s_cbranch_scc0 qkv_auxd
    v_mov_b32 v240, 0
    v_mov_b32 v241, 1
    s_and_b32 s3, s2, 3
    s_mul_i32 s3, s3, 64
    s_mov_b64 exec, 1
    buffer_atomic_add v241, v240, s[24:27], s3 offen sc1
    s_mov_b64 exec, -1
    s_branch qkv_auxd
attn_w1:
    s_waitcnt vmcnt(0)
    s_branch attn_w1d
ffn2_aux:
    s_add_u32 s20, s4, 0x1400000
    s_addc_u32 s21, s5, 0
    s_mov_b32 s22, 0x400000
    s_mov_b32 s23, 0x20000
    s_mov_b32 s24, s48
    s_mov_b32 s25, s49
    s_mov_b32 s26, 0x800
    s_mov_b32 s27, 0x20000
    s_lshl_b32 s41, s31, 18
    s_lshl_b32 s3, s32, 14
    s_add_u32 s41, s41, s3
    s_lshl_b32 s3, s39, 12
    s_add_u32 s41, s41, s3
    s_lshl_b32 s42, s32, 7
    v_lshrrev_b32 v7, 4, v0
    v_lshlrev_b32 v7, 4, v7
    buffer_load_dwordx4 v[140:143], v2, s[20:23], s41 offen offset:0 sc1
    buffer_load_dwordx4 v[144:147], v2, s[20:23], s41 offen offset:1024 sc1
    buffer_load_dwordx4 v[148:151], v2, s[20:23], s41 offen offset:2048 sc1
    buffer_load_dwordx4 v[152:155], v2, s[20:23], s41 offen offset:3072 sc1
    buffer_load_dwordx4 v[156:159], v7, s[24:27], s42 offen offset:0
    buffer_load_dwordx4 v[160:163], v7, s[24:27], s42 offen offset:64
fused_kernel_last:
    s_branch ffn2_auxd
.section .rodata,"a"
.p2align 6
.amdhsa_kernel fused_kernel
  .amdhsa_next_free_vgpr 256
  .amdhsa_next_free_sgpr 102
  .amdhsa_accum_offset 256
  .amdhsa_group_segment_fixed_size 0
  .amdhsa_kernarg_size 88
  .amdhsa_user_sgpr_count 2
  .amdhsa_user_sgpr_kernarg_segment_ptr 1
  .amdhsa_system_sgpr_workgroup_id_x 1
  .amdhsa_float_denorm_mode_32 3
.end_amdhsa_kernel
```
